```python
import torch

def _softmax(x, axis=-1):
    return torch.softmax(x, dim=axis)
def _gelu(x):
    return torch.nn.functional.gelu(x, approximate="tanh")
def _silu(x):
    return torch.nn.functional.silu(x)
def _sigmoid(x):
    return torch.sigmoid(x)
def _layernorm(x, axis=-1, eps=1e-5):
    m = x.mean(dim=axis, keepdim=True)
    v = x.var(dim=axis, keepdim=True, unbiased=False)
    return (x - m) / torch.sqrt(v + eps)
def _scatter_add(tgt, idx, src, axis=0):
    return tgt.clone().index_add_(axis, idx, src)
def _segment_sum(src, seg, n):
    out = torch.zeros((n,) + src.shape[1:], dtype=src.dtype)
    return out.index_add_(0, seg, src)
def _pad(x, pw):
    flat = tuple(v for pair in reversed(pw) for v in pair)
    return torch.nn.functional.pad(x, flat)

kernel_name = 'standalone__gqa_softmax__near_ridge'

def setup_inputs():

    _w = (lambda a: (lambda t: t.to(torch.bfloat16) if t.is_floating_point() else t)(torch.as_tensor(a)))
    B, Hq, Hkv, Sq, Sk, D = 8, 32, 4, 256, 256, 128
    return {
        "q": _w((lambda *s: torch.randn(*s, dtype=torch.bfloat16) * 0.8)(B, Hq, Sq, D)),
        "k": _w((lambda *s: torch.randn(*s, dtype=torch.bfloat16) * 0.8)(B, Hkv, Sk, D)),
        "v": _w((lambda *s: torch.randn(*s, dtype=torch.bfloat16) * 0.05)(B, Hkv, Sk, D)),
    }

def reference(q, k, v):
    B, Hq, Sq, D = q.shape
    Hkv = k.shape[1]
    rep = Hq // Hkv
    k = (lambda x, n, axis: torch.repeat_interleave(x, n, dim=axis))(k, rep, axis=1)
    v = (lambda x, n, axis: torch.repeat_interleave(x, n, dim=axis))(v, rep, axis=1)
    scale = D ** -0.5
    scores = torch.einsum("bhqd,bhkd->bhqk", q, k) * scale
    p = _softmax(scores, axis=-1)
    return torch.einsum("bhqk,bhkd->bhqd", p, v)
```

```asm
; @launch grid=(256,1,1) block=(512,1,1) lds=163840
.amdgcn_target "amdgcn-amd-amdhsa--gfx950"
.text
.globl standalone__gqa_softmax__near_ridge_kernel
.p2align 8
.type standalone__gqa_softmax__near_ridge_kernel,@function
standalone__gqa_softmax__near_ridge_kernel:
    s_load_dwordx4 s[4:7], s[0:1], 0
    s_load_dwordx4 s[8:11], s[0:1], 16
    v_readfirstlane_b32 s28, v0
    s_lshr_b32 s3, s2, 8
    s_cbranch_scc1 L_end
    s_and_b32 s34, s2, 7
    s_lshr_b32 s35, s2, 6
    s_lshl2_add_u32 s34, s34, s35
    s_bfe_u32 s35, s2, 0x30003
    s_lshl3_add_u32 s35, s34, s35
    s_lshl_b32 s34, s34, 16
    s_lshl_b32 s35, s35, 16
    v_and_b32 v0, 63, v0
    s_lshr_b32 s28, s28, 6
    s_and_b32 s36, s28, 3
    s_cmp_lt_u32 s28, 4
    s_cbranch_scc0 L_B
    s_cmp_lg_u32 s28, 0
    s_cbranch_scc1 L_A1
    s_getpc_b64 s[42:43]
L_pc:
    s_sub_u32 s42, s42, (L_pc-standalone__gqa_softmax__near_ridge_kernel)
    s_subb_u32 s43, s43, 0
    s_bfe_u32 s44, s2, 0x30003
    s_mul_i32 s44, s44, 2304
    v_mul_u32_u24 v76, 36, v0
    v_add_u32 v76, s44, v76
    v_min_u32 v76, (L_codeend-standalone__gqa_softmax__near_ridge_kernel-4), v76
    v_mov_b32 v77, s43
    v_add_co_u32 v76, vcc, s42, v76
    s_nop 1
    v_addc_co_u32 v77, vcc, 0, v77, vcc
    global_load_dword v69, v[76:77], off
    s_branch L_A1
L_B:
    v_lshlrev_b32 v70, 4, v0
    v_lshlrev_b32 v71, 2, v0
    v_xor_b32 v71, v70, v71
    v_and_b32 v71, 0xc0, v71
    v_mul_u32_u24 v71, 5, v71
    s_and_b32 s41, s36, 1
    s_mul_i32 s41, s41, 48
    v_xor_b32 v62, v70, v71
    s_lshl_b32 s42, s36, 11
    v_xor_b32 v60, s41, v62
    s_mov_b32 s18, 0x10000
    s_mov_b32 s19, 0x20000
    v_xor_b32 v61, 32, v60
    s_mov_b64 s[14:15], s[18:19]
    s_mov_b32 m0, s42
    s_waitcnt lgkmcnt(0)
    s_add_u32 s16, s6, s34
    s_addc_u32 s17, s7, 0
    buffer_load_dwordx4 v60, s[16:19], m0 offen nt lds
    buffer_load_dwordx4 v61, s[16:19], m0 offen offset:1024 nt lds
    s_add_u32 m0, s42, 131584
    s_add_u32 s12, s4, s35
    s_addc_u32 s13, s5, 0
    buffer_load_dwordx4 v60, s[12:15], s42 offen nt lds
    buffer_load_dwordx4 v61, s[12:15], s42 offen offset:1024 nt lds
    s_lshl_b32 s40, s36, 2
    s_add_u32 s40, s40, 163328
    v_lshl_add_u32 v70, v0, 4, s40
    v_mov_b32 v71, -1
    s_mov_b32 exec_hi, 0
    ds_write_b32 v70, v71
    s_mov_b32 exec_hi, -1
    v_xor_b32 v63, 32, v62
    s_mul_i32 s43, s36, 2064
    s_mov_b64 s[22:23], s[18:19]
    s_lshl_b64 s[100:101], 1, s36
    s_mov_b32 s39, 0x100000
    s_waitcnt lgkmcnt(0)
    s_mov_b32 m0, 163328
    s_mov_b64 exec, s[100:101]
    buffer_load_dword v62, s[16:19], s39 offen lds
    s_mov_b64 exec, -1
    s_add_u32 m0, s42, 8192
    s_nop 0
    buffer_load_dwordx4 v60, s[16:19], m0 offen nt lds
    buffer_load_dwordx4 v61, s[16:19], m0 offen offset:1024 nt lds
    s_add_u32 m0, s42, 139776
    s_add_u32 s49, s42, 8192
    buffer_load_dwordx4 v60, s[12:15], s49 offen nt lds
    buffer_load_dwordx4 v61, s[12:15], s49 offen offset:1024 nt lds
    s_mov_b32 m0, 163344
    s_mov_b64 exec, s[100:101]
    buffer_load_dword v62, s[16:19], s39 offen lds
    s_mov_b64 exec, -1
    s_add_u32 m0, s42, 147968
    s_add_u32 s49, s42, 16384
    buffer_load_dwordx4 v60, s[12:15], s49 offen nt lds
    buffer_load_dwordx4 v61, s[12:15], s49 offen offset:1024 nt lds
    s_mov_b32 m0, 163360
    s_mov_b64 exec, s[100:101]
    buffer_load_dword v62, s[16:19], s39 offen lds
    s_mov_b64 exec, -1
    s_add_u32 m0, s42, 16384
    s_nop 0
    buffer_load_dwordx4 v60, s[16:19], m0 offen nt lds
    buffer_load_dwordx4 v61, s[16:19], m0 offen offset:1024 nt lds
    s_add_u32 m0, s42, 156160
    s_add_u32 s49, s42, 24576
    buffer_load_dwordx4 v60, s[12:15], s49 offen nt lds
    s_cmp_eq_u32 s36, 3
    s_cbranch_scc1 L_noa7
    buffer_load_dwordx4 v61, s[12:15], s49 offen offset:1024 nt lds
L_noa7:
    s_mov_b32 m0, 163376
    s_mov_b64 exec, s[100:101]
    buffer_load_dword v62, s[16:19], s39 offen lds
    s_mov_b64 exec, -1
    s_barrier
    v_xor_b32 v65, 48, v62
    v_xor_b32 v64, 16, v62
    v_and_b32 v70, 15, v0
    v_lshrrev_b32 v71, 4, v0
    v_lshrrev_b32 v72, 2, v70
    v_lshlrev_b32 v73, 1, v72
    v_mov_b32 v74, 0x78
    v_lshrrev_b32 v73, v73, v74
    v_and_b32 v73, 3, v73
    v_xor_b32 v73, v73, v71
    v_lshlrev_b32 v73, 4, v73
    v_lshl_add_u32 v73, v72, 10, v73
    v_and_b32 v74, 3, v0
    v_lshl_add_u32 v1, v74, 6, v73
    s_lshl_b32 s41, s36, 13
    s_add_u32 s41, s41, 131584
    v_add_u32 v66, s41, v1
    s_lshl_b32 s47, s36, 2
    s_add_u32 s47, s47, 163584
    v_mov_b32 v67, s47
    s_mov_b32 s53, 0x40000
    s_cmp_eq_u32 s36, 3
    s_cselect_b32 s50, 0x0fff0fff, -1
    s_mov_b32 s51, s50
    v_lshlrev_b32 v73, 8, v70
    v_lshl_add_u32 v68, v71, 4, v73
    v_lshlrev_b32 v6, 2, v74
    v_add_u32 v6, 163328, v6
    v_lshlrev_b32 v7, 6, v72
    v_lshl_add_u32 v7, v74, 4, v7
    v_mul_u32_u24 v74, 1032, v71
    v_add_u32 v7, v7, v74
    v_add_u32 v2, 65536, v7
    v_mov_b32 v4, v68
    s_lshl_b32 s37, s28, 13
    s_add_u32 s30, s37, 4096
    v_mov_b32 v8, 0
    v_mov_b32 v9, 0
    v_mov_b32 v10, 0
    v_mov_b32 v11, 0
    v_mov_b32 v12, 0
    v_mov_b32 v13, 0
    v_mov_b32 v14, 0
    v_mov_b32 v15, 0
    v_and_b32 v72, 3, v0
    v_cmp_eq_u32 vcc, 0, v72
    v_mov_b32 v72, 0x3f803f80
    s_nop 0
    v_cndmask_b32 v16, 0, v72, vcc
    v_cndmask_b32 v17, 0, v72, vcc
    v_cndmask_b32 v18, 0, v72, vcc
    v_cndmask_b32 v19, 0, v72, vcc
    s_mov_b64 s[32:33], -1
    s_mov_b32 s31, 0x57800000
    s_mov_b32 s38, 0x27800000
    s_mov_b32 s26, 65536
    s_mov_b32 s27, 0x20000
    s_mov_b32 s39, 0x100000
    s_add_u32 s24, s10, s35
    s_addc_u32 s25, s11, 0
    s_add_u32 m0, s43, 65536
    s_add_u32 s20, s8, s34
    s_addc_u32 s21, s9, 0
    buffer_load_dwordx4 v62, s[20:23], s42 offen nt lds
    s_add_u32 m0, m0, 8
    s_nop 0
    buffer_load_dwordx4 v62, s[20:23], s42 offen offset:1024 nt lds
    s_add_u32 m0, s42, 24576
    s_nop 0
    buffer_load_dwordx4 v60, s[16:19], m0 offen nt lds
    buffer_load_dwordx4 v61, s[16:19], m0 offen offset:1024 nt lds
    s_add_u32 m0, s43, 73792
    s_add_u32 s49, s42, 8192
    buffer_load_dwordx4 v62, s[20:23], s49 offen nt lds
    s_add_u32 m0, m0, 8
    s_nop 0
    buffer_load_dwordx4 v62, s[20:23], s49 offen offset:1024 nt lds
    s_mov_b32 m0, 163392
    s_mov_b64 exec, s[100:101]
    buffer_load_dword v62, s[16:19], s39 offen lds
    s_mov_b64 exec, -1
    s_add_u32 m0, s42, 32768
    s_nop 0
    buffer_load_dwordx4 v60, s[16:19], m0 offen nt lds
    buffer_load_dwordx4 v61, s[16:19], m0 offen offset:1024 nt lds
    s_add_u32 m0, s43, 82048
    s_add_u32 s49, s42, 16384
    buffer_load_dwordx4 v62, s[20:23], s49 offen nt lds
    s_add_u32 m0, m0, 8
    s_nop 0
    buffer_load_dwordx4 v62, s[20:23], s49 offen offset:1024 nt lds
    s_add_u32 m0, s42, 40960
    s_nop 0
    buffer_load_dwordx4 v60, s[16:19], m0 offen nt lds
    buffer_load_dwordx4 v61, s[16:19], m0 offen offset:1024 nt lds
    s_mov_b32 m0, 163408
    s_mov_b64 exec, s[100:101]
    buffer_load_dword v62, s[16:19], s39 offen lds
    s_mov_b64 exec, -1
    s_add_u32 m0, s43, 90304
    s_add_u32 s49, s42, 24576
    buffer_load_dwordx4 v62, s[20:23], s49 offen nt lds
    s_add_u32 m0, m0, 8
    s_nop 0
    buffer_load_dwordx4 v62, s[20:23], s49 offen offset:1024 nt lds
    s_add_u32 m0, s42, 49152
    s_nop 0
    buffer_load_dwordx4 v60, s[16:19], m0 offen nt lds
    buffer_load_dwordx4 v61, s[16:19], m0 offen offset:1024 nt lds
    s_add_u32 m0, s43, 98560
    s_add_u32 s49, s42, 32768
    buffer_load_dwordx4 v62, s[20:23], s49 offen nt lds
    s_add_u32 m0, m0, 8
    s_nop 0
    buffer_load_dwordx4 v62, s[20:23], s49 offen offset:1024 nt lds
    s_add_u32 m0, s42, 57344
    s_nop 0
    buffer_load_dwordx4 v60, s[16:19], m0 offen nt lds
    buffer_load_dwordx4 v61, s[16:19], m0 offen offset:1024 nt lds
    s_mov_b32 m0, 163424
    s_mov_b64 exec, s[100:101]
    buffer_load_dword v62, s[16:19], s39 offen lds
    s_mov_b64 exec, -1
    s_add_u32 m0, s43, 106816
    s_add_u32 s49, s42, 40960
    buffer_load_dwordx4 v62, s[20:23], s49 offen nt lds
    s_add_u32 m0, m0, 8
    s_nop 0
    buffer_load_dwordx4 v62, s[20:23], s49 offen offset:1024 nt lds
    s_add_u32 m0, s43, 115072
    s_add_u32 s49, s42, 49152
    buffer_load_dwordx4 v62, s[20:23], s49 offen nt lds
    s_add_u32 m0, m0, 8
    s_nop 0
    buffer_load_dwordx4 v62, s[20:23], s49 offen offset:1024 nt lds
    s_add_u32 m0, s43, 123328
    s_add_u32 s49, s42, 57344
    buffer_load_dwordx4 v62, s[20:23], s49 offen nt lds
    s_add_u32 m0, m0, 8
    s_nop 0
    buffer_load_dwordx4 v62, s[20:23], s49 offen offset:1024 nt lds
    s_mov_b32 m0, 163440
    s_mov_b64 exec, s[100:101]
    buffer_load_dword v62, s[16:19], s39 offen lds
    s_mov_b64 exec, -1
    s_cmp_eq_u32 s36, 3
    s_cbranch_scc0 L_nodb
    s_not_b64 exec, s[50:51]
    s_mov_b32 s48, 61440
    buffer_load_dwordx4 v[44:47], v68, s[12:15], s48 offen offset:0 nt
    buffer_load_dwordx4 v[48:51], v68, s[12:15], s48 offen offset:64 nt
    buffer_load_dwordx4 v[52:55], v68, s[12:15], s48 offen offset:128 nt
    buffer_load_dwordx4 v[56:59], v68, s[12:15], s48 offen offset:192 nt
    s_mov_b64 exec, -1
L_nodb:
L_pqb:
    ds_read_b32 v5, v67 offset:0
    s_sub_u32 s53, s53, 1
    s_cbranch_scc1 L_end
    s_waitcnt lgkmcnt(0)
    v_cmp_ne_u32 vcc, 0, v5
    s_cbranch_vccnz L_pqb
    s_add_u32 m0, s41, 0
    s_sub_u32 s48, s41, 98816
    buffer_load_dwordx4 v62, s[12:15], s48 offen offset:0 nt lds
    buffer_load_dwordx4 v63, s[12:15], s48 offen offset:1024 nt lds
    buffer_load_dwordx4 v65, s[12:15], s48 offen offset:2048 nt lds
    buffer_load_dwordx4 v64, s[12:15], s48 offen offset:3072 nt lds
    s_add_u32 m0, s41, 4096
    s_sub_u32 s48, s41, 94720
    buffer_load_dwordx4 v62, s[12:15], s48 offen offset:0 nt lds
    buffer_load_dwordx4 v63, s[12:15], s48 offen offset:1024 nt lds
    buffer_load_dwordx4 v65, s[12:15], s48 offen offset:2048 nt lds
    s_cmp_eq_u32 s36, 3
    s_cbranch_scc1 L_noq7
    buffer_load_dwordx4 v64, s[12:15], s48 offen offset:3072 nt lds
L_noq7:
    s_mov_b32 s44, 0x3e0293ee
    s_mov_b32 s45, s44
L_pall:
    ds_read_b32 v5, v6 offset:112
    s_sub_u32 s53, s53, 1
    s_cbranch_scc1 L_end
    s_waitcnt lgkmcnt(0)
    v_cmp_ne_u32 vcc, 0, v5
    s_cbranch_vccnz L_pall
    s_setprio 1
    s_waitcnt vmcnt(0)
    ds_read_b128 v[28:31], v66 offset:0
    ds_read_b128 v[32:35], v66 offset:256
    ds_read_b128 v[36:39], v66 offset:512
    ds_read_b128 v[40:43], v66 offset:768
    s_mov_b64 exec, s[50:51]
    ds_read_b128 v[44:47], v66 offset:4096
    ds_read_b128 v[48:51], v66 offset:4352
    ds_read_b128 v[52:55], v66 offset:4608
    ds_read_b128 v[56:59], v66 offset:4864
    s_mov_b64 exec, -1
    ds_read_b128 v[220:223], v1 offset:0
    ds_read_b128 v[224:227], v1 offset:256
    ds_read_b128 v[228:231], v1 offset:512
    ds_read_b128 v[232:235], v1 offset:768
    ds_read_b128 v[236:239], v1 offset:4096
    ds_read_b128 v[240:243], v1 offset:4352
    s_waitcnt lgkmcnt(13)
    v_lshlrev_b32 v124, 16, v28
    v_and_b32 v125, 0xffff0000, v28
    v_lshlrev_b32 v126, 16, v29
    v_and_b32 v127, 0xffff0000, v29
    v_lshlrev_b32 v128, 16, v30
    v_and_b32 v129, 0xffff0000, v30
    v_lshlrev_b32 v130, 16, v31
    v_and_b32 v131, 0xffff0000, v31
    v_mul_f32 v124, 0x3e0293ee, v124
    v_mul_f32 v125, 0x3e0293ee, v125
    v_mul_f32 v126, 0x3e0293ee, v126
    v_mul_f32 v127, 0x3e0293ee, v127
    v_mul_f32 v128, 0x3e0293ee, v128
    v_mul_f32 v129, 0x3e0293ee, v129
    v_mul_f32 v130, 0x3e0293ee, v130
    v_mul_f32 v131, 0x3e0293ee, v131
    v_cvt_pk_bf16_f32 v28, v124, v125
    v_cvt_pk_bf16_f32 v29, v126, v127
    v_cvt_pk_bf16_f32 v30, v128, v129
    v_cvt_pk_bf16_f32 v31, v130, v131
    s_waitcnt lgkmcnt(12)
    v_lshlrev_b32 v132, 16, v32
    v_and_b32 v133, 0xffff0000, v32
    v_lshlrev_b32 v134, 16, v33
    v_and_b32 v135, 0xffff0000, v33
    v_lshlrev_b32 v136, 16, v34
    v_and_b32 v137, 0xffff0000, v34
    v_lshlrev_b32 v138, 16, v35
    v_and_b32 v139, 0xffff0000, v35
    v_mul_f32 v132, 0x3e0293ee, v132
    v_mul_f32 v133, 0x3e0293ee, v133
    v_mul_f32 v134, 0x3e0293ee, v134
    v_mul_f32 v135, 0x3e0293ee, v135
    v_mul_f32 v136, 0x3e0293ee, v136
    v_mul_f32 v137, 0x3e0293ee, v137
    v_mul_f32 v138, 0x3e0293ee, v138
    v_mul_f32 v139, 0x3e0293ee, v139
    v_cvt_pk_bf16_f32 v32, v132, v133
    v_cvt_pk_bf16_f32 v33, v134, v135
    v_cvt_pk_bf16_f32 v34, v136, v137
    v_cvt_pk_bf16_f32 v35, v138, v139
    s_waitcnt lgkmcnt(11)
    v_lshlrev_b32 v124, 16, v36
    v_and_b32 v125, 0xffff0000, v36
    v_lshlrev_b32 v126, 16, v37
    v_and_b32 v127, 0xffff0000, v37
    v_lshlrev_b32 v128, 16, v38
    v_and_b32 v129, 0xffff0000, v38
    v_lshlrev_b32 v130, 16, v39
    v_and_b32 v131, 0xffff0000, v39
    v_mul_f32 v124, 0x3e0293ee, v124
    v_mul_f32 v125, 0x3e0293ee, v125
    v_mul_f32 v126, 0x3e0293ee, v126
    v_mul_f32 v127, 0x3e0293ee, v127
    v_mul_f32 v128, 0x3e0293ee, v128
    v_mul_f32 v129, 0x3e0293ee, v129
    v_mul_f32 v130, 0x3e0293ee, v130
    v_mul_f32 v131, 0x3e0293ee, v131
    v_cvt_pk_bf16_f32 v36, v124, v125
    v_cvt_pk_bf16_f32 v37, v126, v127
    v_cvt_pk_bf16_f32 v38, v128, v129
    v_cvt_pk_bf16_f32 v39, v130, v131
    s_waitcnt lgkmcnt(10)
    v_lshlrev_b32 v132, 16, v40
    v_and_b32 v133, 0xffff0000, v40
    v_lshlrev_b32 v134, 16, v41
    v_and_b32 v135, 0xffff0000, v41
    v_lshlrev_b32 v136, 16, v42
    v_and_b32 v137, 0xffff0000, v42
    v_lshlrev_b32 v138, 16, v43
    v_and_b32 v139, 0xffff0000, v43
    v_mul_f32 v132, 0x3e0293ee, v132
    v_mul_f32 v133, 0x3e0293ee, v133
    v_mul_f32 v134, 0x3e0293ee, v134
    v_mul_f32 v135, 0x3e0293ee, v135
    v_mul_f32 v136, 0x3e0293ee, v136
    v_mul_f32 v137, 0x3e0293ee, v137
    v_mul_f32 v138, 0x3e0293ee, v138
    v_mul_f32 v139, 0x3e0293ee, v139
    v_cvt_pk_bf16_f32 v40, v132, v133
    v_cvt_pk_bf16_f32 v41, v134, v135
    v_cvt_pk_bf16_f32 v42, v136, v137
    v_cvt_pk_bf16_f32 v43, v138, v139
    s_waitcnt lgkmcnt(9)
    v_lshlrev_b32 v124, 16, v44
    v_and_b32 v125, 0xffff0000, v44
    v_lshlrev_b32 v126, 16, v45
    v_and_b32 v127, 0xffff0000, v45
    v_lshlrev_b32 v128, 16, v46
    v_and_b32 v129, 0xffff0000, v46
    v_lshlrev_b32 v130, 16, v47
    v_and_b32 v131, 0xffff0000, v47
    v_mul_f32 v124, 0x3e0293ee, v124
    v_mul_f32 v125, 0x3e0293ee, v125
    v_mul_f32 v126, 0x3e0293ee, v126
    v_mul_f32 v127, 0x3e0293ee, v127
    v_mul_f32 v128, 0x3e0293ee, v128
    v_mul_f32 v129, 0x3e0293ee, v129
    v_mul_f32 v130, 0x3e0293ee, v130
    v_mul_f32 v131, 0x3e0293ee, v131
    v_cvt_pk_bf16_f32 v44, v124, v125
    v_cvt_pk_bf16_f32 v45, v126, v127
    v_cvt_pk_bf16_f32 v46, v128, v129
    v_cvt_pk_bf16_f32 v47, v130, v131
    s_waitcnt lgkmcnt(8)
    v_lshlrev_b32 v132, 16, v48
    v_and_b32 v133, 0xffff0000, v48
    v_lshlrev_b32 v134, 16, v49
    v_and_b32 v135, 0xffff0000, v49
    v_lshlrev_b32 v136, 16, v50
    v_and_b32 v137, 0xffff0000, v50
    v_lshlrev_b32 v138, 16, v51
    v_and_b32 v139, 0xffff0000, v51
    v_mul_f32 v132, 0x3e0293ee, v132
    v_mul_f32 v133, 0x3e0293ee, v133
    v_mul_f32 v134, 0x3e0293ee, v134
    v_mul_f32 v135, 0x3e0293ee, v135
    v_mul_f32 v136, 0x3e0293ee, v136
    v_mul_f32 v137, 0x3e0293ee, v137
    v_mul_f32 v138, 0x3e0293ee, v138
    v_mul_f32 v139, 0x3e0293ee, v139
    v_cvt_pk_bf16_f32 v48, v132, v133
    v_cvt_pk_bf16_f32 v49, v134, v135
    v_cvt_pk_bf16_f32 v50, v136, v137
    v_cvt_pk_bf16_f32 v51, v138, v139
    s_waitcnt lgkmcnt(7)
    v_lshlrev_b32 v124, 16, v52
    v_and_b32 v125, 0xffff0000, v52
    v_lshlrev_b32 v126, 16, v53
    v_and_b32 v127, 0xffff0000, v53
    v_lshlrev_b32 v128, 16, v54
    v_and_b32 v129, 0xffff0000, v54
    v_lshlrev_b32 v130, 16, v55
    v_and_b32 v131, 0xffff0000, v55
    v_mul_f32 v124, 0x3e0293ee, v124
    v_mul_f32 v125, 0x3e0293ee, v125
    v_mul_f32 v126, 0x3e0293ee, v126
    v_mul_f32 v127, 0x3e0293ee, v127
    v_mul_f32 v128, 0x3e0293ee, v128
    v_mul_f32 v129, 0x3e0293ee, v129
    v_mul_f32 v130, 0x3e0293ee, v130
    v_mul_f32 v131, 0x3e0293ee, v131
    v_cvt_pk_bf16_f32 v52, v124, v125
    v_cvt_pk_bf16_f32 v53, v126, v127
    v_cvt_pk_bf16_f32 v54, v128, v129
    v_cvt_pk_bf16_f32 v55, v130, v131
    s_waitcnt lgkmcnt(6)
    v_lshlrev_b32 v132, 16, v56
    v_and_b32 v133, 0xffff0000, v56
    v_lshlrev_b32 v134, 16, v57
    v_and_b32 v135, 0xffff0000, v57
    v_lshlrev_b32 v136, 16, v58
    v_and_b32 v137, 0xffff0000, v58
    v_lshlrev_b32 v138, 16, v59
    v_and_b32 v139, 0xffff0000, v59
    v_mul_f32 v132, 0x3e0293ee, v132
    v_mul_f32 v133, 0x3e0293ee, v133
    v_mul_f32 v134, 0x3e0293ee, v134
    v_mul_f32 v135, 0x3e0293ee, v135
    v_mul_f32 v136, 0x3e0293ee, v136
    v_mul_f32 v137, 0x3e0293ee, v137
    v_mul_f32 v138, 0x3e0293ee, v138
    v_mul_f32 v139, 0x3e0293ee, v139
    v_cvt_pk_bf16_f32 v56, v132, v133
    v_cvt_pk_bf16_f32 v57, v134, v135
    v_cvt_pk_bf16_f32 v58, v136, v137
    v_cvt_pk_bf16_f32 v59, v138, v139
L_mainB:
    s_waitcnt lgkmcnt(5)
    v_mfma_f32_16x16x32_bf16 v[124:127], v[220:223], v[28:31], v[8:11]
    s_waitcnt lgkmcnt(4)
    ds_read_b128 v[244:247], v1 offset:4608
    ds_read_b128 v[248:251], v1 offset:4864
    v_mfma_f32_16x16x32_bf16 v[124:127], v[224:227], v[32:35], v[124:127]
    s_waitcnt lgkmcnt(5)
    ds_read_b128 v[252:255], v1 offset:8192
    v_mfma_f32_16x16x32_bf16 v[124:127], v[228:231], v[36:39], v[124:127]
    s_waitcnt lgkmcnt(5)
    v_mfma_f32_16x16x32_bf16 v[124:127], v[232:235], v[40:43], v[124:127]
    v_mfma_f32_16x16x32_bf16 v[128:131], v[220:223], v[44:47], v[12:15]
    ds_read_b128 v[220:223], v1 offset:8448
    v_mfma_f32_16x16x32_bf16 v[128:131], v[224:227], v[48:51], v[128:131]
    ds_read_b128 v[224:227], v1 offset:8704
    v_mfma_f32_16x16x32_bf16 v[128:131], v[228:231], v[52:55], v[128:131]
    s_nop 2
    v_exp_f32 v124, v124
    v_mfma_f32_16x16x32_bf16 v[128:131], v[232:235], v[56:59], v[128:131]
    s_waitcnt lgkmcnt(6)
    ds_read_b128 v[228:231], v1 offset:8960
    ds_read_b128 v[232:235], v1 offset:12288
    v_mfma_f32_16x16x32_bf16 v[132:135], v[236:239], v[28:31], v[8:11]
    s_waitcnt lgkmcnt(7)
    v_exp_f32 v125, v125
    v_mfma_f32_16x16x32_bf16 v[132:135], v[240:243], v[32:35], v[132:135]
    s_waitcnt lgkmcnt(6)
    v_cvt_pk_bf16_f32 v156, v124, v125
    v_mfma_f32_16x16x32_bf16 v[132:135], v[244:247], v[36:39], v[132:135]
    s_waitcnt lgkmcnt(5)
    v_exp_f32 v126, v126
    v_mfma_f32_16x16x32_bf16 v[132:135], v[248:251], v[40:43], v[132:135]
    v_exp_f32 v127, v127
    v_mfma_f32_16x16x32_bf16 v[136:139], v[236:239], v[44:47], v[12:15]
    ds_read_b128 v[236:239], v1 offset:12544
    v_cvt_pk_bf16_f32 v157, v126, v127
    v_mfma_f32_16x16x32_bf16 v[136:139], v[240:243], v[48:51], v[136:139]
    v_exp_f32 v128, v128
    v_mfma_f32_16x16x32_bf16 v[136:139], v[244:247], v[52:55], v[136:139]
    ds_read_b128 v[240:243], v1 offset:12800
    ds_read_b128 v[244:247], v1 offset:13056
    v_mfma_f32_16x16x32_bf16 v[136:139], v[248:251], v[56:59], v[136:139]
    s_waitcnt lgkmcnt(7)
    v_exp_f32 v129, v129
    v_mfma_f32_16x16x32_bf16 v[140:143], v[252:255], v[28:31], v[8:11]
    s_waitcnt lgkmcnt(6)
    ds_read_b128 v[248:251], v1 offset:16384
    v_cvt_pk_bf16_f32 v160, v128, v129
    v_mfma_f32_16x16x32_bf16 v[140:143], v[220:223], v[32:35], v[140:143]
    s_waitcnt lgkmcnt(6)
    v_exp_f32 v130, v130
    v_mfma_f32_16x16x32_bf16 v[140:143], v[224:227], v[36:39], v[140:143]
    s_waitcnt lgkmcnt(5)
    v_exp_f32 v131, v131
    v_mfma_f32_16x16x32_bf16 v[140:143], v[228:231], v[40:43], v[140:143]
    v_cvt_pk_bf16_f32 v161, v130, v131
    v_mfma_f32_16x16x32_bf16 v[144:147], v[252:255], v[44:47], v[12:15]
    v_exp_f32 v132, v132
    v_mfma_f32_16x16x32_bf16 v[144:147], v[220:223], v[48:51], v[144:147]
    ds_read_b128 v[252:255], v1 offset:16640
    ds_read_b128 v[220:223], v1 offset:16896
    v_mfma_f32_16x16x32_bf16 v[144:147], v[224:227], v[52:55], v[144:147]
    v_exp_f32 v133, v133
    v_mfma_f32_16x16x32_bf16 v[144:147], v[228:231], v[56:59], v[144:147]
    s_waitcnt lgkmcnt(6)
    ds_read_b128 v[224:227], v1 offset:17152
    v_cvt_pk_bf16_f32 v158, v132, v133
    v_mfma_f32_16x16x32_bf16 v[148:151], v[232:235], v[28:31], v[8:11]
    s_waitcnt lgkmcnt(6)
    v_exp_f32 v134, v134
    v_mfma_f32_16x16x32_bf16 v[148:151], v[236:239], v[32:35], v[148:151]
    s_waitcnt lgkmcnt(5)
    ds_read_b128 v[228:231], v1 offset:20480
    v_mfma_f32_16x16x32_bf16 v[148:151], v[240:243], v[36:39], v[148:151]
    s_waitcnt lgkmcnt(5)
    v_exp_f32 v135, v135
    v_mfma_f32_16x16x32_bf16 v[148:151], v[244:247], v[40:43], v[148:151]
    v_cvt_pk_bf16_f32 v159, v134, v135
    v_mfma_f32_16x16x32_bf16 v[152:155], v[232:235], v[44:47], v[12:15]
    v_exp_f32 v136, v136
    v_mfma_f32_16x16x32_bf16 v[152:155], v[236:239], v[48:51], v[152:155]
    v_exp_f32 v137, v137
    v_mfma_f32_16x16x32_bf16 v[152:155], v[240:243], v[52:55], v[152:155]
    v_cvt_pk_bf16_f32 v162, v136, v137
    v_exp_f32 v138, v138
    v_mfma_f32_16x16x32_bf16 v[152:155], v[244:247], v[56:59], v[152:155]
    s_waitcnt lgkmcnt(4)
    ds_read_b128 v[232:235], v1 offset:20736
    ds_read_b128 v[236:239], v1 offset:20992
    v_mfma_f32_16x16x32_bf16 v[124:127], v[248:251], v[28:31], v[8:11]
    s_waitcnt lgkmcnt(5)
    v_exp_f32 v139, v139
    v_mfma_f32_16x16x32_bf16 v[124:127], v[252:255], v[32:35], v[124:127]
    s_waitcnt lgkmcnt(4)
    v_cvt_pk_bf16_f32 v163, v138, v139
    v_exp_f32 v140, v140
    v_mfma_f32_16x16x32_bf16 v[124:127], v[220:223], v[36:39], v[124:127]
    s_waitcnt lgkmcnt(3)
    ds_read_b128 v[240:243], v1 offset:21248
    ds_read_b128 v[244:247], v1 offset:24576
    v_mfma_f32_16x16x32_bf16 v[124:127], v[224:227], v[40:43], v[124:127]
    v_exp_f32 v141, v141
    v_mfma_f32_16x16x32_bf16 v[128:131], v[248:251], v[44:47], v[12:15]
    v_cvt_pk_bf16_f32 v164, v140, v141
    v_exp_f32 v142, v142
    v_mfma_f32_16x16x32_bf16 v[128:131], v[252:255], v[48:51], v[128:131]
    v_exp_f32 v143, v143
    v_mfma_f32_16x16x32_bf16 v[128:131], v[220:223], v[52:55], v[128:131]
    v_cvt_pk_bf16_f32 v165, v142, v143
    v_exp_f32 v144, v144
    v_mfma_f32_16x16x32_bf16 v[128:131], v[224:227], v[56:59], v[128:131]
    v_exp_f32 v145, v145
    v_mfma_f32_16x16x32_bf16 v[20:23], v[16:19], v[156:159], 0
    v_cvt_pk_bf16_f32 v168, v144, v145
    v_exp_f32 v146, v146
    v_mfma_f32_16x16x32_bf16 v[24:27], v[16:19], v[160:163], 0
    s_waitcnt lgkmcnt(4)
    ds_read_b128 v[248:251], v1 offset:24832
    v_exp_f32 v147, v147
    v_mfma_f32_16x16x32_bf16 v[132:135], v[228:231], v[28:31], v[8:11]
    s_waitcnt lgkmcnt(4)
    ds_read_b128 v[252:255], v1 offset:25088
    v_cvt_pk_bf16_f32 v169, v146, v147
    v_exp_f32 v148, v148
    v_mfma_f32_16x16x32_bf16 v[132:135], v[232:235], v[32:35], v[132:135]
    s_waitcnt lgkmcnt(4)
    ds_read_b128 v[220:223], v1 offset:25344
    v_exp_f32 v149, v149
    v_mfma_f32_16x16x32_bf16 v[132:135], v[236:239], v[36:39], v[132:135]
    s_waitcnt lgkmcnt(4)
    v_cvt_pk_bf16_f32 v166, v148, v149
    v_exp_f32 v150, v150
    v_mfma_f32_16x16x32_bf16 v[132:135], v[240:243], v[40:43], v[132:135]
    v_exp_f32 v151, v151
    v_mfma_f32_16x16x32_bf16 v[136:139], v[228:231], v[44:47], v[12:15]
    v_cvt_pk_bf16_f32 v167, v150, v151
    v_exp_f32 v152, v152
    v_mfma_f32_16x16x32_bf16 v[136:139], v[232:235], v[48:51], v[136:139]
    v_exp_f32 v153, v153
    v_mfma_f32_16x16x32_bf16 v[136:139], v[236:239], v[52:55], v[136:139]
    v_cvt_pk_bf16_f32 v170, v152, v153
    v_exp_f32 v154, v154
    v_mfma_f32_16x16x32_bf16 v[136:139], v[240:243], v[56:59], v[136:139]
    s_waitcnt lgkmcnt(3)
    v_exp_f32 v155, v155
    v_mfma_f32_16x16x32_bf16 v[140:143], v[244:247], v[28:31], v[8:11]
    s_waitcnt lgkmcnt(2)
    ds_read_b128 v[224:227], v1 offset:28672
    v_cvt_pk_bf16_f32 v171, v154, v155
    v_exp_f32 v124, v124
    v_mfma_f32_16x16x32_bf16 v[140:143], v[248:251], v[32:35], v[140:143]
    s_waitcnt lgkmcnt(2)
    ds_read_b128 v[228:231], v1 offset:28928
    ds_read_b128 v[232:235], v1 offset:29184
    v_mfma_f32_16x16x32_bf16 v[140:143], v[252:255], v[36:39], v[140:143]
    s_waitcnt lgkmcnt(3)
    v_exp_f32 v125, v125
    v_mfma_f32_16x16x32_bf16 v[140:143], v[220:223], v[40:43], v[140:143]
    ds_read_b128 v[236:239], v1 offset:29440
    v_cvt_pk_bf16_f32 v172, v124, v125
    v_mfma_f32_16x16x32_bf16 v[144:147], v[244:247], v[44:47], v[12:15]
    v_exp_f32 v126, v126
    v_mfma_f32_16x16x32_bf16 v[144:147], v[248:251], v[48:51], v[144:147]
    v_exp_f32 v127, v127
    v_mfma_f32_16x16x32_bf16 v[144:147], v[252:255], v[52:55], v[144:147]
    v_cvt_pk_bf16_f32 v173, v126, v127
    v_exp_f32 v128, v128
    v_mfma_f32_16x16x32_bf16 v[144:147], v[220:223], v[56:59], v[144:147]
    v_exp_f32 v129, v129
    v_mfma_f32_16x16x32_bf16 v[20:23], v[16:19], v[164:167], v[20:23]
    ds_read_b128 v[240:243], v1 offset:32768
    v_cvt_pk_bf16_f32 v176, v128, v129
    v_exp_f32 v130, v130
    v_mfma_f32_16x16x32_bf16 v[24:27], v[16:19], v[168:171], v[24:27]
    s_waitcnt lgkmcnt(4)
    ds_read_b128 v[244:247], v1 offset:33024
    v_exp_f32 v131, v131
    v_mfma_f32_16x16x32_bf16 v[148:151], v[224:227], v[28:31], v[8:11]
    s_waitcnt lgkmcnt(4)
    ds_read_b128 v[248:251], v1 offset:33280
    v_cvt_pk_bf16_f32 v177, v130, v131
    v_exp_f32 v132, v132
    v_mfma_f32_16x16x32_bf16 v[148:151], v[228:231], v[32:35], v[148:151]
    s_waitcnt lgkmcnt(4)
    ds_read_b128 v[252:255], v1 offset:33536
    v_exp_f32 v133, v133
    v_mfma_f32_16x16x32_bf16 v[148:151], v[232:235], v[36:39], v[148:151]
    s_waitcnt lgkmcnt(4)
    v_cvt_pk_bf16_f32 v174, v132, v133
    v_exp_f32 v134, v134
    v_mfma_f32_16x16x32_bf16 v[148:151], v[236:239], v[40:43], v[148:151]
    v_exp_f32 v135, v135
    v_mfma_f32_16x16x32_bf16 v[152:155], v[224:227], v[44:47], v[12:15]
    v_cvt_pk_bf16_f32 v175, v134, v135
    v_exp_f32 v136, v136
    v_mfma_f32_16x16x32_bf16 v[152:155], v[228:231], v[48:51], v[152:155]
    v_exp_f32 v137, v137
    v_mfma_f32_16x16x32_bf16 v[152:155], v[232:235], v[52:55], v[152:155]
    v_cvt_pk_bf16_f32 v178, v136, v137
    v_exp_f32 v138, v138
    v_mfma_f32_16x16x32_bf16 v[152:155], v[236:239], v[56:59], v[152:155]
    s_waitcnt lgkmcnt(3)
    v_exp_f32 v139, v139
    v_mfma_f32_16x16x32_bf16 v[124:127], v[240:243], v[28:31], v[8:11]
    s_waitcnt lgkmcnt(2)
    ds_read_b128 v[220:223], v1 offset:36864
    v_cvt_pk_bf16_f32 v179, v138, v139
    v_exp_f32 v140, v140
    v_mfma_f32_16x16x32_bf16 v[124:127], v[244:247], v[32:35], v[124:127]
    s_waitcnt lgkmcnt(2)
    ds_read_b128 v[224:227], v1 offset:37120
    ds_read_b128 v[228:231], v1 offset:37376
    v_mfma_f32_16x16x32_bf16 v[124:127], v[248:251], v[36:39], v[124:127]
    s_waitcnt lgkmcnt(3)
    v_exp_f32 v141, v141
    v_mfma_f32_16x16x32_bf16 v[124:127], v[252:255], v[40:43], v[124:127]
    ds_read_b128 v[232:235], v1 offset:37632
    v_cvt_pk_bf16_f32 v180, v140, v141
    v_mfma_f32_16x16x32_bf16 v[128:131], v[240:243], v[44:47], v[12:15]
    v_exp_f32 v142, v142
    v_mfma_f32_16x16x32_bf16 v[128:131], v[244:247], v[48:51], v[128:131]
    v_exp_f32 v143, v143
    v_mfma_f32_16x16x32_bf16 v[128:131], v[248:251], v[52:55], v[128:131]
    v_cvt_pk_bf16_f32 v181, v142, v143
    v_exp_f32 v144, v144
    v_mfma_f32_16x16x32_bf16 v[128:131], v[252:255], v[56:59], v[128:131]
    v_exp_f32 v145, v145
    v_mfma_f32_16x16x32_bf16 v[20:23], v[16:19], v[172:175], v[20:23]
    ds_read_b128 v[236:239], v1 offset:40960
    v_cvt_pk_bf16_f32 v184, v144, v145
    v_exp_f32 v146, v146
    v_mfma_f32_16x16x32_bf16 v[24:27], v[16:19], v[176:179], v[24:27]
    s_waitcnt lgkmcnt(4)
    ds_read_b128 v[240:243], v1 offset:41216
    v_exp_f32 v147, v147
    v_mfma_f32_16x16x32_bf16 v[132:135], v[220:223], v[28:31], v[8:11]
    s_waitcnt lgkmcnt(4)
    ds_read_b128 v[244:247], v1 offset:41472
    v_cvt_pk_bf16_f32 v185, v146, v147
    v_exp_f32 v148, v148
    v_mfma_f32_16x16x32_bf16 v[132:135], v[224:227], v[32:35], v[132:135]
    s_waitcnt lgkmcnt(4)
    ds_read_b128 v[248:251], v1 offset:41728
    v_exp_f32 v149, v149
    v_mfma_f32_16x16x32_bf16 v[132:135], v[228:231], v[36:39], v[132:135]
    s_waitcnt lgkmcnt(4)
    v_cvt_pk_bf16_f32 v182, v148, v149
    v_exp_f32 v150, v150
    v_mfma_f32_16x16x32_bf16 v[132:135], v[232:235], v[40:43], v[132:135]
    v_exp_f32 v151, v151
    v_mfma_f32_16x16x32_bf16 v[136:139], v[220:223], v[44:47], v[12:15]
    v_cvt_pk_bf16_f32 v183, v150, v151
    v_exp_f32 v152, v152
    v_mfma_f32_16x16x32_bf16 v[136:139], v[224:227], v[48:51], v[136:139]
    v_exp_f32 v153, v153
    v_mfma_f32_16x16x32_bf16 v[136:139], v[228:231], v[52:55], v[136:139]
    v_cvt_pk_bf16_f32 v186, v152, v153
    v_exp_f32 v154, v154
    v_mfma_f32_16x16x32_bf16 v[136:139], v[232:235], v[56:59], v[136:139]
    s_waitcnt lgkmcnt(3)
    v_exp_f32 v155, v155
    v_mfma_f32_16x16x32_bf16 v[140:143], v[236:239], v[28:31], v[8:11]
    s_waitcnt lgkmcnt(2)
    ds_read_b128 v[252:255], v1 offset:45056
    v_cvt_pk_bf16_f32 v187, v154, v155
    v_exp_f32 v124, v124
    v_mfma_f32_16x16x32_bf16 v[140:143], v[240:243], v[32:35], v[140:143]
    s_waitcnt lgkmcnt(2)
    ds_read_b128 v[220:223], v1 offset:45312
    ds_read_b128 v[224:227], v1 offset:45568
    v_mfma_f32_16x16x32_bf16 v[140:143], v[244:247], v[36:39], v[140:143]
    s_waitcnt lgkmcnt(3)
    v_exp_f32 v125, v125
    v_mfma_f32_16x16x32_bf16 v[140:143], v[248:251], v[40:43], v[140:143]
    ds_read_b128 v[228:231], v1 offset:45824
    v_cvt_pk_bf16_f32 v188, v124, v125
    v_mfma_f32_16x16x32_bf16 v[144:147], v[236:239], v[44:47], v[12:15]
    v_exp_f32 v126, v126
    v_mfma_f32_16x16x32_bf16 v[144:147], v[240:243], v[48:51], v[144:147]
    v_exp_f32 v127, v127
    v_mfma_f32_16x16x32_bf16 v[144:147], v[244:247], v[52:55], v[144:147]
    v_cvt_pk_bf16_f32 v189, v126, v127
    v_exp_f32 v128, v128
    v_mfma_f32_16x16x32_bf16 v[144:147], v[248:251], v[56:59], v[144:147]
    v_exp_f32 v129, v129
    v_mfma_f32_16x16x32_bf16 v[20:23], v[16:19], v[180:183], v[20:23]
    ds_read_b128 v[232:235], v1 offset:49152
    v_cvt_pk_bf16_f32 v192, v128, v129
    v_exp_f32 v130, v130
    v_mfma_f32_16x16x32_bf16 v[24:27], v[16:19], v[184:187], v[24:27]
    s_waitcnt lgkmcnt(4)
    ds_read_b128 v[236:239], v1 offset:49408
    v_exp_f32 v131, v131
    v_mfma_f32_16x16x32_bf16 v[148:151], v[252:255], v[28:31], v[8:11]
    s_waitcnt lgkmcnt(4)
    ds_read_b128 v[240:243], v1 offset:49664
    v_cvt_pk_bf16_f32 v193, v130, v131
    v_exp_f32 v132, v132
    v_mfma_f32_16x16x32_bf16 v[148:151], v[220:223], v[32:35], v[148:151]
    s_waitcnt lgkmcnt(4)
    ds_read_b128 v[244:247], v1 offset:49920
    v_exp_f32 v133, v133
    v_mfma_f32_16x16x32_bf16 v[148:151], v[224:227], v[36:39], v[148:151]
    s_waitcnt lgkmcnt(4)
    v_cvt_pk_bf16_f32 v190, v132, v133
    v_exp_f32 v134, v134
    v_mfma_f32_16x16x32_bf16 v[148:151], v[228:231], v[40:43], v[148:151]
    v_exp_f32 v135, v135
    v_mfma_f32_16x16x32_bf16 v[152:155], v[252:255], v[44:47], v[12:15]
    v_cvt_pk_bf16_f32 v191, v134, v135
    v_exp_f32 v136, v136
    v_mfma_f32_16x16x32_bf16 v[152:155], v[220:223], v[48:51], v[152:155]
    v_exp_f32 v137, v137
    v_mfma_f32_16x16x32_bf16 v[152:155], v[224:227], v[52:55], v[152:155]
    v_cvt_pk_bf16_f32 v194, v136, v137
    v_exp_f32 v138, v138
    v_mfma_f32_16x16x32_bf16 v[152:155], v[228:231], v[56:59], v[152:155]
    s_waitcnt lgkmcnt(3)
    v_exp_f32 v139, v139
    v_mfma_f32_16x16x32_bf16 v[124:127], v[232:235], v[28:31], v[8:11]
    s_waitcnt lgkmcnt(2)
    ds_read_b128 v[248:251], v1 offset:53248
    v_cvt_pk_bf16_f32 v195, v138, v139
    v_exp_f32 v140, v140
    v_mfma_f32_16x16x32_bf16 v[124:127], v[236:239], v[32:35], v[124:127]
    s_waitcnt lgkmcnt(2)
    ds_read_b128 v[252:255], v1 offset:53504
    v_exp_f32 v141, v141
    v_mfma_f32_16x16x32_bf16 v[124:127], v[240:243], v[36:39], v[124:127]
    s_waitcnt lgkmcnt(2)
    ds_read_b128 v[220:223], v1 offset:53760
    v_cvt_pk_bf16_f32 v196, v140, v141
    v_exp_f32 v142, v142
    v_mfma_f32_16x16x32_bf16 v[124:127], v[244:247], v[40:43], v[124:127]
    ds_read_b128 v[224:227], v1 offset:54016
    v_exp_f32 v143, v143
    v_mfma_f32_16x16x32_bf16 v[128:131], v[232:235], v[44:47], v[12:15]
    v_cvt_pk_bf16_f32 v197, v142, v143
    v_exp_f32 v144, v144
    v_mfma_f32_16x16x32_bf16 v[128:131], v[236:239], v[48:51], v[128:131]
    v_exp_f32 v145, v145
    v_mfma_f32_16x16x32_bf16 v[128:131], v[240:243], v[52:55], v[128:131]
    v_cvt_pk_bf16_f32 v200, v144, v145
    v_exp_f32 v146, v146
    v_mfma_f32_16x16x32_bf16 v[128:131], v[244:247], v[56:59], v[128:131]
    v_exp_f32 v147, v147
    v_mfma_f32_16x16x32_bf16 v[20:23], v[16:19], v[188:191], v[20:23]
    ds_read_b128 v[228:231], v1 offset:57344
    v_cvt_pk_bf16_f32 v201, v146, v147
    v_exp_f32 v148, v148
    v_mfma_f32_16x16x32_bf16 v[24:27], v[16:19], v[192:195], v[24:27]
    s_waitcnt lgkmcnt(4)
    ds_read_b128 v[232:235], v1 offset:57600
    v_exp_f32 v149, v149
    v_mfma_f32_16x16x32_bf16 v[132:135], v[248:251], v[28:31], v[8:11]
    s_waitcnt lgkmcnt(4)
    ds_read_b128 v[236:239], v1 offset:57856
    v_cvt_pk_bf16_f32 v198, v148, v149
    v_exp_f32 v150, v150
    v_mfma_f32_16x16x32_bf16 v[132:135], v[252:255], v[32:35], v[132:135]
    s_waitcnt lgkmcnt(4)
    ds_read_b128 v[240:243], v1 offset:58112
    v_exp_f32 v151, v151
    v_mfma_f32_16x16x32_bf16 v[132:135], v[220:223], v[36:39], v[132:135]
    s_waitcnt lgkmcnt(4)
    v_cvt_pk_bf16_f32 v199, v150, v151
    v_exp_f32 v152, v152
    v_mfma_f32_16x16x32_bf16 v[132:135], v[224:227], v[40:43], v[132:135]
    v_exp_f32 v153, v153
    v_mfma_f32_16x16x32_bf16 v[136:139], v[248:251], v[44:47], v[12:15]
    v_cvt_pk_bf16_f32 v202, v152, v153
    v_exp_f32 v154, v154
    v_mfma_f32_16x16x32_bf16 v[136:139], v[252:255], v[48:51], v[136:139]
    v_exp_f32 v155, v155
    v_mfma_f32_16x16x32_bf16 v[136:139], v[220:223], v[52:55], v[136:139]
    v_cvt_pk_bf16_f32 v203, v154, v155
    v_exp_f32 v124, v124
    v_mfma_f32_16x16x32_bf16 v[136:139], v[224:227], v[56:59], v[136:139]
    s_waitcnt lgkmcnt(3)
    v_exp_f32 v125, v125
    v_mfma_f32_16x16x32_bf16 v[140:143], v[228:231], v[28:31], v[8:11]
    s_waitcnt lgkmcnt(2)
    ds_read_b128 v[244:247], v1 offset:61440
    v_cvt_pk_bf16_f32 v204, v124, v125
    v_exp_f32 v126, v126
    v_mfma_f32_16x16x32_bf16 v[140:143], v[232:235], v[32:35], v[140:143]
    s_waitcnt lgkmcnt(2)
    ds_read_b128 v[248:251], v1 offset:61696
    v_exp_f32 v127, v127
    v_mfma_f32_16x16x32_bf16 v[140:143], v[236:239], v[36:39], v[140:143]
    s_waitcnt lgkmcnt(2)
    ds_read_b128 v[252:255], v1 offset:61952
    v_cvt_pk_bf16_f32 v205, v126, v127
    v_exp_f32 v128, v128
    v_mfma_f32_16x16x32_bf16 v[140:143], v[240:243], v[40:43], v[140:143]
    ds_read_b128 v[220:223], v1 offset:62208
    v_exp_f32 v129, v129
    v_mfma_f32_16x16x32_bf16 v[144:147], v[228:231], v[44:47], v[12:15]
    v_cvt_pk_bf16_f32 v208, v128, v129
    v_exp_f32 v130, v130
    v_mfma_f32_16x16x32_bf16 v[144:147], v[232:235], v[48:51], v[144:147]
    v_exp_f32 v131, v131
    v_mfma_f32_16x16x32_bf16 v[144:147], v[236:239], v[52:55], v[144:147]
    v_cvt_pk_bf16_f32 v209, v130, v131
    v_exp_f32 v132, v132
    v_mfma_f32_16x16x32_bf16 v[144:147], v[240:243], v[56:59], v[144:147]
    v_exp_f32 v133, v133
    v_mfma_f32_16x16x32_bf16 v[20:23], v[16:19], v[196:199], v[20:23]
    v_cvt_pk_bf16_f32 v206, v132, v133
    v_exp_f32 v134, v134
    v_mfma_f32_16x16x32_bf16 v[24:27], v[16:19], v[200:203], v[24:27]
    s_waitcnt lgkmcnt(3)
    v_exp_f32 v135, v135
    v_mfma_f32_16x16x32_bf16 v[148:151], v[244:247], v[28:31], v[8:11]
    s_waitcnt lgkmcnt(2)
    ds_read_b64_tr_b16 v[224:225], v2 offset:0
    ds_read_b64_tr_b16 v[226:227], v2 offset:4128
    v_exp_f32 v136, v136
    v_mfma_f32_16x16x32_bf16 v[148:151], v[248:251], v[32:35], v[148:151]
    s_waitcnt lgkmcnt(3)
    ds_read_b64_tr_b16 v[228:229], v2 offset:8256
    ds_read_b64_tr_b16 v[230:231], v2 offset:12384
    v_exp_f32 v137, v137
    v_mfma_f32_16x16x32_bf16 v[148:151], v[252:255], v[36:39], v[148:151]
    s_waitcnt lgkmcnt(4)
    ds_read_b64_tr_b16 v[232:233], v2 offset:16512
    ds_read_b64_tr_b16 v[234:235], v2 offset:20640
    v_exp_f32 v138, v138
    v_mfma_f32_16x16x32_bf16 v[148:151], v[220:223], v[40:43], v[148:151]
    ds_read_b64_tr_b16 v[236:237], v2 offset:24768
    ds_read_b64_tr_b16 v[238:239], v2 offset:28896
    v_exp_f32 v139, v139
    v_mfma_f32_16x16x32_bf16 v[152:155], v[244:247], v[44:47], v[12:15]
    v_cvt_pk_bf16_f32 v207, v134, v135
    v_cvt_pk_bf16_f32 v210, v136, v137
    v_mfma_f32_16x16x32_bf16 v[152:155], v[248:251], v[48:51], v[152:155]
    v_cvt_pk_bf16_f32 v211, v138, v139
    v_exp_f32 v140, v140
    v_mfma_f32_16x16x32_bf16 v[152:155], v[252:255], v[52:55], v[152:155]
    v_exp_f32 v141, v141
    v_mfma_f32_16x16x32_bf16 v[152:155], v[220:223], v[56:59], v[152:155]
    v_cvt_pk_bf16_f32 v212, v140, v141
    v_exp_f32 v142, v142
    v_mfma_f32_16x16x32_bf16 v[20:23], v[16:19], v[204:207], v[20:23]
    v_exp_f32 v143, v143
    v_mfma_f32_16x16x32_bf16 v[24:27], v[16:19], v[208:211], v[24:27]
    s_waitcnt lgkmcnt(6)
    v_cvt_pk_bf16_f32 v213, v142, v143
    v_exp_f32 v144, v144
    v_mfma_f32_16x16x32_bf16 v[60:63], v[224:227], v[156:159], 0
    s_waitcnt lgkmcnt(4)
    ds_read_b64_tr_b16 v[240:241], v2 offset:33024
    ds_read_b64_tr_b16 v[242:243], v2 offset:37152
    v_exp_f32 v145, v145
    v_mfma_f32_16x16x32_bf16 v[60:63], v[228:231], v[164:167], v[60:63]
    s_waitcnt lgkmcnt(4)
    ds_read_b64_tr_b16 v[244:245], v2 offset:41280
    ds_read_b64_tr_b16 v[246:247], v2 offset:45408
    v_exp_f32 v146, v146
    v_mfma_f32_16x16x32_bf16 v[60:63], v[232:235], v[172:175], v[60:63]
    s_waitcnt lgkmcnt(4)
    ds_read_b64_tr_b16 v[248:249], v2 offset:49536
    ds_read_b64_tr_b16 v[250:251], v2 offset:53664
    v_exp_f32 v147, v147
    v_mfma_f32_16x16x32_bf16 v[60:63], v[236:239], v[180:183], v[60:63]
    ds_read_b64_tr_b16 v[252:253], v2 offset:57792
    ds_read_b64_tr_b16 v[254:255], v2 offset:61920
    v_exp_f32 v148, v148
    v_mfma_f32_16x16x32_bf16 v[64:67], v[224:227], v[160:163], 0
    v_cvt_pk_bf16_f32 v216, v144, v145
    v_exp_f32 v149, v149
    v_mfma_f32_16x16x32_bf16 v[64:67], v[228:231], v[168:171], v[64:67]
    v_cvt_pk_bf16_f32 v217, v146, v147
    v_exp_f32 v150, v150
    v_mfma_f32_16x16x32_bf16 v[64:67], v[232:235], v[176:179], v[64:67]
    v_cvt_pk_bf16_f32 v214, v148, v149
    v_exp_f32 v151, v151
    v_mfma_f32_16x16x32_bf16 v[64:67], v[236:239], v[184:187], v[64:67]
    v_cvt_pk_bf16_f32 v215, v150, v151
    v_exp_f32 v152, v152
    s_nop 0
    v_mfma_f32_16x16x32_bf16 v[20:23], v[16:19], v[212:215], v[20:23]
    ds_read_b64_tr_b16 v[220:221], v2 offset:8
    ds_read_b64_tr_b16 v[222:223], v2 offset:4136
    v_exp_f32 v153, v153
    v_exp_f32 v154, v154
    v_cvt_pk_bf16_f32 v218, v152, v153
    v_exp_f32 v155, v155
    s_nop 0
    v_cvt_pk_bf16_f32 v219, v154, v155
    s_nop 1
    v_mfma_f32_16x16x32_bf16 v[24:27], v[16:19], v[216:219], v[24:27]
    s_waitcnt lgkmcnt(8)
    ds_read_b64_tr_b16 v[224:225], v2 offset:8264
    ds_read_b64_tr_b16 v[226:227], v2 offset:12392
    v_mfma_f32_16x16x32_bf16 v[60:63], v[240:243], v[188:191], v[60:63]
    s_waitcnt lgkmcnt(8)
    ds_read_b64_tr_b16 v[228:229], v2 offset:16520
    ds_read_b64_tr_b16 v[230:231], v2 offset:20648
    v_mfma_f32_16x16x32_bf16 v[60:63], v[244:247], v[196:199], v[60:63]
    s_waitcnt lgkmcnt(8)
    ds_read_b64_tr_b16 v[232:233], v2 offset:24776
    ds_read_b64_tr_b16 v[234:235], v2 offset:28904
    v_mfma_f32_16x16x32_bf16 v[60:63], v[248:251], v[204:207], v[60:63]
    s_waitcnt lgkmcnt(8)
    ds_read_b64_tr_b16 v[236:237], v2 offset:33032
    v_max_f32 v7, v20, v24
    v_mfma_f32_16x16x32_bf16 v[60:63], v[252:255], v[212:215], v[60:63]
    ds_read_b64_tr_b16 v[238:239], v2 offset:37160
    v_min_f32 v0, v20, v24
    v_mfma_f32_16x16x32_bf16 v[64:67], v[240:243], v[192:195], v[64:67]
    ds_read_b64_tr_b16 v[240:241], v2 offset:41288
    v_cmp_ngt_f32 s[42:43], s31, v7
    v_mfma_f32_16x16x32_bf16 v[64:67], v[244:247], v[200:203], v[64:67]
    ds_read_b64_tr_b16 v[242:243], v2 offset:45416
    v_cmp_nlt_f32 s[48:49], s38, v0
    v_mfma_f32_16x16x32_bf16 v[64:67], v[248:251], v[208:211], v[64:67]
    ds_read_b64_tr_b16 v[244:245], v2 offset:49544
    v_rcp_f32 v20, v20
    v_mfma_f32_16x16x32_bf16 v[64:67], v[252:255], v[216:219], v[64:67]
    s_waitcnt lgkmcnt(11)
    ds_read_b64_tr_b16 v[246:247], v2 offset:53672
    v_rcp_f32 v24, v24
    v_mfma_f32_16x16x32_bf16 v[68:71], v[220:223], v[156:159], 0
    s_waitcnt lgkmcnt(10)
    ds_read_b64_tr_b16 v[248:249], v2 offset:57800
    s_or_b64 s[42:43], s[42:43], s[48:49]
    s_and_b64 s[42:43], s[42:43], s[32:33]
    s_cbranch_scc1 L_slow
    v_mfma_f32_16x16x32_bf16 v[68:71], v[224:227], v[164:167], v[68:71]
    s_waitcnt lgkmcnt(9)
    ds_read_b64_tr_b16 v[250:251], v2 offset:61928
    v_mul_f32 v60, v60, v20
    v_mfma_f32_16x16x32_bf16 v[68:71], v[228:231], v[172:175], v[68:71]
    s_waitcnt lgkmcnt(8)
    ds_read_b64_tr_b16 v[252:253], v2 offset:256
    v_mul_f32 v61, v61, v20
    v_mfma_f32_16x16x32_bf16 v[68:71], v[232:235], v[180:183], v[68:71]
    ds_read_b64_tr_b16 v[254:255], v2 offset:4384
    v_mul_f32 v62, v62, v20
    v_mfma_f32_16x16x32_bf16 v[72:75], v[220:223], v[160:163], 0
    ds_read_b64_tr_b16 v[220:221], v2 offset:8512
    v_mul_f32 v63, v63, v20
    v_mfma_f32_16x16x32_bf16 v[72:75], v[224:227], v[168:171], v[72:75]
    ds_read_b64_tr_b16 v[222:223], v2 offset:12640
    v_cvt_pk_bf16_f32 v124, v60, v61
    v_mfma_f32_16x16x32_bf16 v[72:75], v[228:231], v[176:179], v[72:75]
    ds_read_b64_tr_b16 v[224:225], v2 offset:16768
    v_cvt_pk_bf16_f32 v125, v62, v63
    v_mfma_f32_16x16x32_bf16 v[72:75], v[232:235], v[184:187], v[72:75]
    s_waitcnt lgkmcnt(11)
    ds_read_b64_tr_b16 v[226:227], v2 offset:20896
    v_mul_f32 v64, v64, v24
    v_mfma_f32_16x16x32_bf16 v[68:71], v[236:239], v[188:191], v[68:71]
    s_waitcnt lgkmcnt(10)
    ds_read_b64_tr_b16 v[228:229], v2 offset:25024
    v_mul_f32 v65, v65, v24
    v_mfma_f32_16x16x32_bf16 v[68:71], v[240:243], v[196:199], v[68:71]
    s_waitcnt lgkmcnt(9)
    ds_read_b64_tr_b16 v[230:231], v2 offset:29152
    v_mul_f32 v66, v66, v24
    v_mfma_f32_16x16x32_bf16 v[68:71], v[244:247], v[204:207], v[68:71]
    s_waitcnt lgkmcnt(8)
    ds_read_b64_tr_b16 v[232:233], v2 offset:33280
    v_mul_f32 v67, v67, v24
    v_mfma_f32_16x16x32_bf16 v[68:71], v[248:251], v[212:215], v[68:71]
    ds_read_b64_tr_b16 v[234:235], v2 offset:37408
    v_cvt_pk_bf16_f32 v128, v64, v65
    v_mfma_f32_16x16x32_bf16 v[72:75], v[236:239], v[192:195], v[72:75]
    ds_read_b64_tr_b16 v[236:237], v2 offset:41536
    v_cvt_pk_bf16_f32 v129, v66, v67
    v_mfma_f32_16x16x32_bf16 v[72:75], v[240:243], v[200:203], v[72:75]
    ds_read_b64_tr_b16 v[238:239], v2 offset:45664
    ds_read_b64_tr_b16 v[240:241], v2 offset:49792
    v_mfma_f32_16x16x32_bf16 v[72:75], v[244:247], v[208:211], v[72:75]
    ds_read_b64_tr_b16 v[242:243], v2 offset:53920
    v_mul_f32 v68, v68, v20
    v_mfma_f32_16x16x32_bf16 v[72:75], v[248:251], v[216:219], v[72:75]
    s_waitcnt lgkmcnt(12)
    ds_read_b64_tr_b16 v[244:245], v2 offset:58048
    v_mul_f32 v69, v69, v20
    v_mfma_f32_16x16x32_bf16 v[76:79], v[252:255], v[156:159], 0
    s_waitcnt lgkmcnt(11)
    ds_read_b64_tr_b16 v[246:247], v2 offset:62176
    v_mul_f32 v70, v70, v20
    v_mfma_f32_16x16x32_bf16 v[76:79], v[220:223], v[164:167], v[76:79]
    s_waitcnt lgkmcnt(10)
    ds_read_b64_tr_b16 v[248:249], v2 offset:264
    v_mul_f32 v71, v71, v20
    v_mfma_f32_16x16x32_bf16 v[76:79], v[224:227], v[172:175], v[76:79]
    s_waitcnt lgkmcnt(9)
    ds_read_b64_tr_b16 v[250:251], v2 offset:4392
    v_cvt_pk_bf16_f32 v126, v68, v69
    v_mfma_f32_16x16x32_bf16 v[76:79], v[228:231], v[180:183], v[76:79]
    v_cvt_pk_bf16_f32 v127, v70, v71
    v_mfma_f32_16x16x32_bf16 v[80:83], v[252:255], v[160:163], 0
    ds_read_b64_tr_b16 v[252:253], v2 offset:8520
    buffer_store_dwordx4 v[124:127], v4, s[24:27], s37 offen offset:0 sc1 nt
    v_mfma_f32_16x16x32_bf16 v[80:83], v[220:223], v[168:171], v[80:83]
    ds_read_b64_tr_b16 v[254:255], v2 offset:12648
    v_mul_f32 v72, v72, v24
    v_mfma_f32_16x16x32_bf16 v[80:83], v[224:227], v[176:179], v[80:83]
    ds_read_b64_tr_b16 v[220:221], v2 offset:16776
    v_mul_f32 v73, v73, v24
    v_mfma_f32_16x16x32_bf16 v[80:83], v[228:231], v[184:187], v[80:83]
    s_waitcnt lgkmcnt(11)
    ds_read_b64_tr_b16 v[222:223], v2 offset:20904
    v_mul_f32 v74, v74, v24
    v_mfma_f32_16x16x32_bf16 v[76:79], v[232:235], v[188:191], v[76:79]
    s_waitcnt lgkmcnt(10)
    ds_read_b64_tr_b16 v[224:225], v2 offset:25032
    v_mul_f32 v75, v75, v24
    v_mfma_f32_16x16x32_bf16 v[76:79], v[236:239], v[196:199], v[76:79]
    s_waitcnt lgkmcnt(9)
    ds_read_b64_tr_b16 v[226:227], v2 offset:29160
    v_cvt_pk_bf16_f32 v130, v72, v73
    v_mfma_f32_16x16x32_bf16 v[76:79], v[240:243], v[204:207], v[76:79]
    s_waitcnt lgkmcnt(8)
    ds_read_b64_tr_b16 v[228:229], v2 offset:33288
    v_cvt_pk_bf16_f32 v131, v74, v75
    v_mfma_f32_16x16x32_bf16 v[76:79], v[244:247], v[212:215], v[76:79]
    ds_read_b64_tr_b16 v[230:231], v2 offset:37416
    buffer_store_dwordx4 v[128:131], v4, s[24:27], s30 offen offset:0 sc1 nt
    v_mfma_f32_16x16x32_bf16 v[80:83], v[232:235], v[192:195], v[80:83]
    ds_read_b64_tr_b16 v[232:233], v2 offset:41544
    ds_read_b64_tr_b16 v[234:235], v2 offset:45672
    v_mfma_f32_16x16x32_bf16 v[80:83], v[236:239], v[200:203], v[80:83]
    ds_read_b64_tr_b16 v[236:237], v2 offset:49800
    ds_read_b64_tr_b16 v[238:239], v2 offset:53928
    v_mfma_f32_16x16x32_bf16 v[80:83], v[240:243], v[208:211], v[80:83]
    ds_read_b64_tr_b16 v[240:241], v2 offset:58056
    v_mul_f32 v76, v76, v20
    v_mfma_f32_16x16x32_bf16 v[80:83], v[244:247], v[216:219], v[80:83]
    s_waitcnt lgkmcnt(13)
    ds_read_b64_tr_b16 v[242:243], v2 offset:62184
    v_mul_f32 v77, v77, v20
    v_mfma_f32_16x16x32_bf16 v[84:87], v[248:251], v[156:159], 0
    s_waitcnt lgkmcnt(12)
    ds_read_b64_tr_b16 v[244:245], v2 offset:512
    v_mul_f32 v78, v78, v20
    v_mfma_f32_16x16x32_bf16 v[84:87], v[252:255], v[164:167], v[84:87]
    s_waitcnt lgkmcnt(11)
    ds_read_b64_tr_b16 v[246:247], v2 offset:4640
    v_mul_f32 v79, v79, v20
    v_mfma_f32_16x16x32_bf16 v[84:87], v[220:223], v[172:175], v[84:87]
    s_waitcnt lgkmcnt(10)
    v_cvt_pk_bf16_f32 v132, v76, v77
    v_cvt_pk_bf16_f32 v133, v78, v79
    v_mfma_f32_16x16x32_bf16 v[84:87], v[224:227], v[180:183], v[84:87]
    v_mul_f32 v80, v80, v24
    v_mul_f32 v81, v81, v24
    v_mfma_f32_16x16x32_bf16 v[88:91], v[248:251], v[160:163], 0
    ds_read_b64_tr_b16 v[248:249], v2 offset:8768
    v_mul_f32 v82, v82, v24
    v_mfma_f32_16x16x32_bf16 v[88:91], v[252:255], v[168:171], v[88:91]
    ds_read_b64_tr_b16 v[250:251], v2 offset:12896
    v_mul_f32 v83, v83, v24
    v_mfma_f32_16x16x32_bf16 v[88:91], v[220:223], v[176:179], v[88:91]
    ds_read_b64_tr_b16 v[252:253], v2 offset:17024
    v_cvt_pk_bf16_f32 v136, v80, v81
    v_mfma_f32_16x16x32_bf16 v[88:91], v[224:227], v[184:187], v[88:91]
    s_waitcnt lgkmcnt(11)
    ds_read_b64_tr_b16 v[254:255], v2 offset:21152
    v_cvt_pk_bf16_f32 v137, v82, v83
    v_mfma_f32_16x16x32_bf16 v[84:87], v[228:231], v[188:191], v[84:87]
    s_waitcnt lgkmcnt(10)
    ds_read_b64_tr_b16 v[220:221], v2 offset:25280
    ds_read_b64_tr_b16 v[222:223], v2 offset:29408
    v_mfma_f32_16x16x32_bf16 v[84:87], v[232:235], v[196:199], v[84:87]
    s_waitcnt lgkmcnt(10)
    ds_read_b64_tr_b16 v[224:225], v2 offset:33536
    ds_read_b64_tr_b16 v[226:227], v2 offset:37664
    v_mfma_f32_16x16x32_bf16 v[84:87], v[236:239], v[204:207], v[84:87]
    s_waitcnt lgkmcnt(10)
    v_mfma_f32_16x16x32_bf16 v[84:87], v[240:243], v[212:215], v[84:87]
    v_mfma_f32_16x16x32_bf16 v[88:91], v[228:231], v[192:195], v[88:91]
    ds_read_b64_tr_b16 v[228:229], v2 offset:41792
    ds_read_b64_tr_b16 v[230:231], v2 offset:45920
    v_mfma_f32_16x16x32_bf16 v[88:91], v[232:235], v[200:203], v[88:91]
    ds_read_b64_tr_b16 v[232:233], v2 offset:50048
    ds_read_b64_tr_b16 v[234:235], v2 offset:54176
    v_mfma_f32_16x16x32_bf16 v[88:91], v[236:239], v[208:211], v[88:91]
    ds_read_b64_tr_b16 v[236:237], v2 offset:58304
    v_mul_f32 v84, v84, v20
    v_mfma_f32_16x16x32_bf16 v[88:91], v[240:243], v[216:219], v[88:91]
    s_waitcnt lgkmcnt(13)
    ds_read_b64_tr_b16 v[238:239], v2 offset:62432
    v_mul_f32 v85, v85, v20
    v_mfma_f32_16x16x32_bf16 v[92:95], v[244:247], v[156:159], 0
    s_waitcnt lgkmcnt(12)
    ds_read_b64_tr_b16 v[240:241], v2 offset:520
    v_mul_f32 v86, v86, v20
    v_mfma_f32_16x16x32_bf16 v[92:95], v[248:251], v[164:167], v[92:95]
    s_waitcnt lgkmcnt(11)
    ds_read_b64_tr_b16 v[242:243], v2 offset:4648
    v_mul_f32 v87, v87, v20
    v_mfma_f32_16x16x32_bf16 v[92:95], v[252:255], v[172:175], v[92:95]
    s_waitcnt lgkmcnt(10)
    v_cvt_pk_bf16_f32 v134, v84, v85
    v_cvt_pk_bf16_f32 v135, v86, v87
    v_mfma_f32_16x16x32_bf16 v[92:95], v[220:223], v[180:183], v[92:95]
    buffer_store_dwordx4 v[132:135], v4, s[24:27], s37 offen offset:64 sc1 nt
    v_mfma_f32_16x16x32_bf16 v[96:99], v[244:247], v[160:163], 0
    ds_read_b64_tr_b16 v[244:245], v2 offset:8776
    v_mul_f32 v88, v88, v24
    v_mfma_f32_16x16x32_bf16 v[96:99], v[248:251], v[168:171], v[96:99]
    ds_read_b64_tr_b16 v[246:247], v2 offset:12904
    v_mul_f32 v89, v89, v24
    v_mfma_f32_16x16x32_bf16 v[96:99], v[252:255], v[176:179], v[96:99]
    ds_read_b64_tr_b16 v[248:249], v2 offset:17032
    v_mul_f32 v90, v90, v24
    v_mfma_f32_16x16x32_bf16 v[96:99], v[220:223], v[184:187], v[96:99]
    s_waitcnt lgkmcnt(11)
    ds_read_b64_tr_b16 v[250:251], v2 offset:21160
    v_mul_f32 v91, v91, v24
    v_mfma_f32_16x16x32_bf16 v[92:95], v[224:227], v[188:191], v[92:95]
    s_waitcnt lgkmcnt(10)
    ds_read_b64_tr_b16 v[252:253], v2 offset:25288
    v_cvt_pk_bf16_f32 v138, v88, v89
    v_mfma_f32_16x16x32_bf16 v[92:95], v[228:231], v[196:199], v[92:95]
    s_waitcnt lgkmcnt(9)
    ds_read_b64_tr_b16 v[254:255], v2 offset:29416
    v_cvt_pk_bf16_f32 v139, v90, v91
    v_mfma_f32_16x16x32_bf16 v[92:95], v[232:235], v[204:207], v[92:95]
    s_waitcnt lgkmcnt(8)
    ds_read_b64_tr_b16 v[220:221], v2 offset:33544
    buffer_store_dwordx4 v[136:139], v4, s[24:27], s30 offen offset:64 sc1 nt
    v_mfma_f32_16x16x32_bf16 v[92:95], v[236:239], v[212:215], v[92:95]
    ds_read_b64_tr_b16 v[222:223], v2 offset:37672
    v_mfma_f32_16x16x32_bf16 v[96:99], v[224:227], v[192:195], v[96:99]
    ds_read_b64_tr_b16 v[224:225], v2 offset:41800
    ds_read_b64_tr_b16 v[226:227], v2 offset:45928
    v_mfma_f32_16x16x32_bf16 v[96:99], v[228:231], v[200:203], v[96:99]
    ds_read_b64_tr_b16 v[228:229], v2 offset:50056
    ds_read_b64_tr_b16 v[230:231], v2 offset:54184
    v_mfma_f32_16x16x32_bf16 v[96:99], v[232:235], v[208:211], v[96:99]
    ds_read_b64_tr_b16 v[232:233], v2 offset:58312
    v_mul_f32 v92, v92, v20
    v_mfma_f32_16x16x32_bf16 v[96:99], v[236:239], v[216:219], v[96:99]
    s_waitcnt lgkmcnt(13)
    ds_read_b64_tr_b16 v[234:235], v2 offset:62440
    v_mul_f32 v93, v93, v20
    v_mfma_f32_16x16x32_bf16 v[100:103], v[240:243], v[156:159], 0
    s_waitcnt lgkmcnt(12)
    ds_read_b64_tr_b16 v[236:237], v2 offset:768
    v_mul_f32 v94, v94, v20
    v_mfma_f32_16x16x32_bf16 v[100:103], v[244:247], v[164:167], v[100:103]
    s_waitcnt lgkmcnt(11)
    ds_read_b64_tr_b16 v[238:239], v2 offset:4896
    v_mul_f32 v95, v95, v20
    v_mfma_f32_16x16x32_bf16 v[100:103], v[248:251], v[172:175], v[100:103]
    s_waitcnt lgkmcnt(10)
    v_cvt_pk_bf16_f32 v124, v92, v93
    v_cvt_pk_bf16_f32 v125, v94, v95
    v_mfma_f32_16x16x32_bf16 v[100:103], v[252:255], v[180:183], v[100:103]
    v_mul_f32 v96, v96, v24
    v_mul_f32 v97, v97, v24
    v_mfma_f32_16x16x32_bf16 v[104:107], v[240:243], v[160:163], 0
    ds_read_b64_tr_b16 v[240:241], v2 offset:9024
    v_mul_f32 v98, v98, v24
    v_mfma_f32_16x16x32_bf16 v[104:107], v[244:247], v[168:171], v[104:107]
    ds_read_b64_tr_b16 v[242:243], v2 offset:13152
    v_mul_f32 v99, v99, v24
    v_mfma_f32_16x16x32_bf16 v[104:107], v[248:251], v[176:179], v[104:107]
    ds_read_b64_tr_b16 v[244:245], v2 offset:17280
    v_cvt_pk_bf16_f32 v128, v96, v97
    v_mfma_f32_16x16x32_bf16 v[104:107], v[252:255], v[184:187], v[104:107]
    s_waitcnt lgkmcnt(11)
    ds_read_b64_tr_b16 v[246:247], v2 offset:21408
    v_cvt_pk_bf16_f32 v129, v98, v99
    v_mfma_f32_16x16x32_bf16 v[100:103], v[220:223], v[188:191], v[100:103]
    s_waitcnt lgkmcnt(10)
    ds_read_b64_tr_b16 v[248:249], v2 offset:25536
    ds_read_b64_tr_b16 v[250:251], v2 offset:29664
    v_mfma_f32_16x16x32_bf16 v[100:103], v[224:227], v[196:199], v[100:103]
    s_waitcnt lgkmcnt(10)
    ds_read_b64_tr_b16 v[252:253], v2 offset:33792
    ds_read_b64_tr_b16 v[254:255], v2 offset:37920
    v_mfma_f32_16x16x32_bf16 v[100:103], v[228:231], v[204:207], v[100:103]
    s_waitcnt lgkmcnt(10)
    v_mfma_f32_16x16x32_bf16 v[100:103], v[232:235], v[212:215], v[100:103]
    v_mfma_f32_16x16x32_bf16 v[104:107], v[220:223], v[192:195], v[104:107]
    ds_read_b64_tr_b16 v[220:221], v2 offset:42048
    ds_read_b64_tr_b16 v[222:223], v2 offset:46176
    v_mfma_f32_16x16x32_bf16 v[104:107], v[224:227], v[200:203], v[104:107]
    ds_read_b64_tr_b16 v[224:225], v2 offset:50304
    ds_read_b64_tr_b16 v[226:227], v2 offset:54432
    v_mfma_f32_16x16x32_bf16 v[104:107], v[228:231], v[208:211], v[104:107]
    ds_read_b64_tr_b16 v[228:229], v2 offset:58560
    v_mul_f32 v100, v100, v20
    v_mfma_f32_16x16x32_bf16 v[104:107], v[232:235], v[216:219], v[104:107]
    s_waitcnt lgkmcnt(13)
    ds_read_b64_tr_b16 v[230:231], v2 offset:62688
    v_mul_f32 v101, v101, v20
    v_mfma_f32_16x16x32_bf16 v[108:111], v[236:239], v[156:159], 0
    s_waitcnt lgkmcnt(12)
    ds_read_b64_tr_b16 v[232:233], v2 offset:776
    v_mul_f32 v102, v102, v20
    v_mfma_f32_16x16x32_bf16 v[108:111], v[240:243], v[164:167], v[108:111]
    s_waitcnt lgkmcnt(11)
    ds_read_b64_tr_b16 v[234:235], v2 offset:4904
    v_mul_f32 v103, v103, v20
    v_mfma_f32_16x16x32_bf16 v[108:111], v[244:247], v[172:175], v[108:111]
    s_waitcnt lgkmcnt(10)
    v_cvt_pk_bf16_f32 v126, v100, v101
    v_cvt_pk_bf16_f32 v127, v102, v103
    v_mfma_f32_16x16x32_bf16 v[108:111], v[248:251], v[180:183], v[108:111]
    buffer_store_dwordx4 v[124:127], v4, s[24:27], s37 offen offset:128 sc1 nt
    v_mfma_f32_16x16x32_bf16 v[112:115], v[236:239], v[160:163], 0
    ds_read_b64_tr_b16 v[236:237], v2 offset:9032
    v_mul_f32 v104, v104, v24
    v_mfma_f32_16x16x32_bf16 v[112:115], v[240:243], v[168:171], v[112:115]
    ds_read_b64_tr_b16 v[238:239], v2 offset:13160
    v_mul_f32 v105, v105, v24
    v_mfma_f32_16x16x32_bf16 v[112:115], v[244:247], v[176:179], v[112:115]
    ds_read_b64_tr_b16 v[240:241], v2 offset:17288
    v_mul_f32 v106, v106, v24
    v_mfma_f32_16x16x32_bf16 v[112:115], v[248:251], v[184:187], v[112:115]
    s_waitcnt lgkmcnt(11)
    ds_read_b64_tr_b16 v[242:243], v2 offset:21416
    v_mul_f32 v107, v107, v24
    v_mfma_f32_16x16x32_bf16 v[108:111], v[252:255], v[188:191], v[108:111]
    s_waitcnt lgkmcnt(10)
    ds_read_b64_tr_b16 v[244:245], v2 offset:25544
    v_cvt_pk_bf16_f32 v130, v104, v105
    v_mfma_f32_16x16x32_bf16 v[108:111], v[220:223], v[196:199], v[108:111]
    s_waitcnt lgkmcnt(9)
    ds_read_b64_tr_b16 v[246:247], v2 offset:29672
    v_cvt_pk_bf16_f32 v131, v106, v107
    v_mfma_f32_16x16x32_bf16 v[108:111], v[224:227], v[204:207], v[108:111]
    s_waitcnt lgkmcnt(8)
    ds_read_b64_tr_b16 v[248:249], v2 offset:33800
    buffer_store_dwordx4 v[128:131], v4, s[24:27], s30 offen offset:128 sc1 nt
    v_mfma_f32_16x16x32_bf16 v[108:111], v[228:231], v[212:215], v[108:111]
    ds_read_b64_tr_b16 v[250:251], v2 offset:37928
    v_mfma_f32_16x16x32_bf16 v[112:115], v[252:255], v[192:195], v[112:115]
    ds_read_b64_tr_b16 v[252:253], v2 offset:42056
    ds_read_b64_tr_b16 v[254:255], v2 offset:46184
    v_mfma_f32_16x16x32_bf16 v[112:115], v[220:223], v[200:203], v[112:115]
    ds_read_b64_tr_b16 v[220:221], v2 offset:50312
    ds_read_b64_tr_b16 v[222:223], v2 offset:54440
    v_mfma_f32_16x16x32_bf16 v[112:115], v[224:227], v[208:211], v[112:115]
    ds_read_b64_tr_b16 v[224:225], v2 offset:58568
    v_mul_f32 v108, v108, v20
    v_mfma_f32_16x16x32_bf16 v[112:115], v[228:231], v[216:219], v[112:115]
    s_waitcnt lgkmcnt(13)
    ds_read_b64_tr_b16 v[226:227], v2 offset:62696
    v_mul_f32 v109, v109, v20
    v_mfma_f32_16x16x32_bf16 v[116:119], v[232:235], v[156:159], 0
    s_waitcnt lgkmcnt(12)
    v_mul_f32 v110, v110, v20
    v_mul_f32 v111, v111, v20
    v_mfma_f32_16x16x32_bf16 v[116:119], v[236:239], v[164:167], v[116:119]
    s_waitcnt lgkmcnt(10)
    v_cvt_pk_bf16_f32 v132, v108, v109
    v_cvt_pk_bf16_f32 v133, v110, v111
    v_mfma_f32_16x16x32_bf16 v[116:119], v[240:243], v[172:175], v[116:119]
    s_waitcnt lgkmcnt(8)
    v_mul_f32 v112, v112, v24
    v_mul_f32 v113, v113, v24
    v_mfma_f32_16x16x32_bf16 v[116:119], v[244:247], v[180:183], v[116:119]
    v_mul_f32 v114, v114, v24
    v_mul_f32 v115, v115, v24
    v_mfma_f32_16x16x32_bf16 v[120:123], v[232:235], v[160:163], 0
    v_cvt_pk_bf16_f32 v136, v112, v113
    v_cvt_pk_bf16_f32 v137, v114, v115
    v_mfma_f32_16x16x32_bf16 v[120:123], v[236:239], v[168:171], v[120:123]
    v_mfma_f32_16x16x32_bf16 v[120:123], v[240:243], v[176:179], v[120:123]
    v_mfma_f32_16x16x32_bf16 v[120:123], v[244:247], v[184:187], v[120:123]
    s_waitcnt lgkmcnt(6)
    v_mfma_f32_16x16x32_bf16 v[116:119], v[248:251], v[188:191], v[116:119]
    s_waitcnt lgkmcnt(4)
    v_mfma_f32_16x16x32_bf16 v[116:119], v[252:255], v[196:199], v[116:119]
    s_waitcnt lgkmcnt(2)
    v_mfma_f32_16x16x32_bf16 v[116:119], v[220:223], v[204:207], v[116:119]
    s_waitcnt lgkmcnt(0)
    v_mfma_f32_16x16x32_bf16 v[116:119], v[224:227], v[212:215], v[116:119]
    v_mfma_f32_16x16x32_bf16 v[120:123], v[248:251], v[192:195], v[120:123]
    v_mfma_f32_16x16x32_bf16 v[120:123], v[252:255], v[200:203], v[120:123]
    v_mfma_f32_16x16x32_bf16 v[120:123], v[220:223], v[208:211], v[120:123]
    s_nop 4
    v_mul_f32 v116, v116, v20
    v_mul_f32 v117, v117, v20
    v_mfma_f32_16x16x32_bf16 v[120:123], v[224:227], v[216:219], v[120:123]
    v_mul_f32 v118, v118, v20
    v_mul_f32 v119, v119, v20
    v_cvt_pk_bf16_f32 v134, v116, v117
    v_cvt_pk_bf16_f32 v135, v118, v119
    buffer_store_dwordx4 v[132:135], v4, s[24:27], s37 offen offset:192 sc1 nt
    s_nop 2
    v_pk_mul_f32 v[120:121], v[120:121], v[24:25] op_sel_hi:[1,0]
    v_pk_mul_f32 v[122:123], v[122:123], v[24:25] op_sel_hi:[1,0]
    v_cvt_pk_bf16_f32 v138, v120, v121
    v_cvt_pk_bf16_f32 v139, v122, v123
    buffer_store_dwordx4 v[136:139], v4, s[24:27], s30 offen offset:192 sc1 nt
L_fin:
L_end:
    s_endpgm
L_A:
L_A1:
    s_setprio 1
    v_and_b32 v70, 15, v0
    v_lshrrev_b32 v71, 4, v0
    v_lshrrev_b32 v72, 2, v70
    v_lshlrev_b32 v73, 1, v72
    v_mov_b32 v74, 0x78
    v_lshrrev_b32 v73, v73, v74
    v_and_b32 v73, 3, v73
    v_xor_b32 v73, v73, v71
    v_lshlrev_b32 v73, 4, v73
    v_lshl_add_u32 v73, v72, 10, v73
    v_and_b32 v74, 3, v0
    v_lshl_add_u32 v1, v74, 6, v73
    s_lshl_b32 s41, s36, 13
    s_add_u32 s41, s41, 131584
    v_add_u32 v66, s41, v1
    s_lshl_b32 s47, s36, 2
    s_add_u32 s47, s47, 163584
    v_mov_b32 v67, s47
    s_mov_b32 s53, 0x40000
    s_cmp_eq_u32 s36, 3
    s_cselect_b32 s50, 0x0fff0fff, -1
    s_mov_b32 s51, s50
    v_lshlrev_b32 v73, 8, v70
    v_lshl_add_u32 v68, v71, 4, v73
    v_lshlrev_b32 v6, 2, v74
    v_add_u32 v6, 163328, v6
    v_lshlrev_b32 v7, 6, v72
    v_lshl_add_u32 v7, v74, 4, v7
    v_mul_u32_u24 v74, 1032, v71
    v_add_u32 v7, v7, v74
    v_add_u32 v2, 65536, v7
    v_mov_b32 v4, v68
    s_lshl_b32 s37, s28, 13
    s_add_u32 s30, s37, 4096
    v_mov_b32 v8, 0
    v_mov_b32 v9, 0
    v_mov_b32 v10, 0
    v_mov_b32 v11, 0
    v_mov_b32 v12, 0
    v_mov_b32 v13, 0
    v_mov_b32 v14, 0
    v_mov_b32 v15, 0
    v_and_b32 v72, 3, v0
    v_cmp_eq_u32 vcc, 0, v72
    v_mov_b32 v72, 0x3f803f80
    s_nop 0
    v_cndmask_b32 v16, 0, v72, vcc
    v_cndmask_b32 v17, 0, v72, vcc
    v_cndmask_b32 v18, 0, v72, vcc
    v_cndmask_b32 v19, 0, v72, vcc
    s_mov_b64 s[32:33], -1
    s_mov_b32 s31, 0x57800000
    s_mov_b32 s38, 0x27800000
    s_mov_b32 s26, 65536
    s_mov_b32 s27, 0x20000
    s_mov_b32 s39, 0x100000
    s_mov_b32 s14, 0x10000
    s_mov_b32 s15, 0x20000
    s_mov_b32 s44, 0x3e0293ee
    s_mov_b32 s45, s44
    s_mov_b32 s48, 0
    s_cmp_eq_u32 s36, 1
    s_cselect_b32 s48, 16, s48
    s_cmp_eq_u32 s36, 2
    s_cselect_b32 s48, 32, s48
    s_cmp_eq_u32 s36, 3
    s_cselect_b32 s48, 48, s48
    v_add_u32 v70, s48, v6
    s_waitcnt lgkmcnt(0)
    s_add_u32 s12, s4, s35
    s_addc_u32 s13, s5, 0
    s_cmp_eq_u32 s36, 3
    s_cbranch_scc0 L_noda
    s_not_b64 exec, s[50:51]
    s_mov_b32 s48, 28672
    buffer_load_dwordx4 v[44:47], v68, s[12:15], s48 offen offset:0 nt
    buffer_load_dwordx4 v[48:51], v68, s[12:15], s48 offen offset:64 nt
    buffer_load_dwordx4 v[52:55], v68, s[12:15], s48 offen offset:128 nt
    buffer_load_dwordx4 v[56:59], v68, s[12:15], s48 offen offset:192 nt
    s_mov_b64 exec, -1
L_noda:
    s_add_u32 s24, s10, s35
    s_addc_u32 s25, s11, 0
    s_barrier
    s_waitcnt vmcnt(0)
L_pstart:
    ds_read_b32 v5, v70 offset:0
    s_sub_u32 s53, s53, 1
    s_cbranch_scc1 L_end
    s_waitcnt lgkmcnt(0)
    v_cmp_ne_u32 vcc, 0, v5
    s_cbranch_vccnz L_pstart
    ds_read_b128 v[28:31], v66 offset:0
    ds_read_b128 v[32:35], v66 offset:256
    ds_read_b128 v[36:39], v66 offset:512
    ds_read_b128 v[40:43], v66 offset:768
    s_mov_b64 exec, s[50:51]
    ds_read_b128 v[44:47], v66 offset:4096
    ds_read_b128 v[48:51], v66 offset:4352
    ds_read_b128 v[52:55], v66 offset:4608
    ds_read_b128 v[56:59], v66 offset:4864
    s_mov_b64 exec, -1
    ds_read_b128 v[220:223], v1 offset:0
    ds_read_b128 v[224:227], v1 offset:256
    ds_read_b128 v[228:231], v1 offset:512
    ds_read_b128 v[232:235], v1 offset:768
    ds_read_b128 v[236:239], v1 offset:4096
    s_waitcnt lgkmcnt(12)
    v_lshlrev_b32 v124, 16, v28
    v_and_b32 v125, 0xffff0000, v28
    v_lshlrev_b32 v126, 16, v29
    v_and_b32 v127, 0xffff0000, v29
    v_lshlrev_b32 v128, 16, v30
    v_and_b32 v129, 0xffff0000, v30
    v_lshlrev_b32 v130, 16, v31
    v_and_b32 v131, 0xffff0000, v31
    v_pk_mul_f32 v[124:125], v[124:125], s[44:45]
    v_pk_mul_f32 v[126:127], v[126:127], s[44:45]
    v_pk_mul_f32 v[128:129], v[128:129], s[44:45]
    v_pk_mul_f32 v[130:131], v[130:131], s[44:45]
    v_cvt_pk_bf16_f32 v28, v124, v125
    v_cvt_pk_bf16_f32 v29, v126, v127
    v_cvt_pk_bf16_f32 v30, v128, v129
    v_cvt_pk_bf16_f32 v31, v130, v131
    s_waitcnt lgkmcnt(11)
    v_lshlrev_b32 v132, 16, v32
    v_and_b32 v133, 0xffff0000, v32
    v_lshlrev_b32 v134, 16, v33
    v_and_b32 v135, 0xffff0000, v33
    v_lshlrev_b32 v136, 16, v34
    v_and_b32 v137, 0xffff0000, v34
    v_lshlrev_b32 v138, 16, v35
    v_and_b32 v139, 0xffff0000, v35
    v_pk_mul_f32 v[132:133], v[132:133], s[44:45]
    v_pk_mul_f32 v[134:135], v[134:135], s[44:45]
    v_pk_mul_f32 v[136:137], v[136:137], s[44:45]
    v_pk_mul_f32 v[138:139], v[138:139], s[44:45]
    v_cvt_pk_bf16_f32 v32, v132, v133
    v_cvt_pk_bf16_f32 v33, v134, v135
    v_cvt_pk_bf16_f32 v34, v136, v137
    v_cvt_pk_bf16_f32 v35, v138, v139
    s_waitcnt lgkmcnt(10)
    v_lshlrev_b32 v124, 16, v36
    v_and_b32 v125, 0xffff0000, v36
    v_lshlrev_b32 v126, 16, v37
    v_and_b32 v127, 0xffff0000, v37
    v_lshlrev_b32 v128, 16, v38
    v_and_b32 v129, 0xffff0000, v38
    v_lshlrev_b32 v130, 16, v39
    v_and_b32 v131, 0xffff0000, v39
    v_pk_mul_f32 v[124:125], v[124:125], s[44:45]
    v_pk_mul_f32 v[126:127], v[126:127], s[44:45]
    v_pk_mul_f32 v[128:129], v[128:129], s[44:45]
    v_pk_mul_f32 v[130:131], v[130:131], s[44:45]
    v_cvt_pk_bf16_f32 v36, v124, v125
    v_cvt_pk_bf16_f32 v37, v126, v127
    v_cvt_pk_bf16_f32 v38, v128, v129
    v_cvt_pk_bf16_f32 v39, v130, v131
    s_waitcnt lgkmcnt(9)
    v_lshlrev_b32 v132, 16, v40
    v_and_b32 v133, 0xffff0000, v40
    v_lshlrev_b32 v134, 16, v41
    v_and_b32 v135, 0xffff0000, v41
    v_lshlrev_b32 v136, 16, v42
    v_and_b32 v137, 0xffff0000, v42
    v_lshlrev_b32 v138, 16, v43
    v_and_b32 v139, 0xffff0000, v43
    v_pk_mul_f32 v[132:133], v[132:133], s[44:45]
    v_pk_mul_f32 v[134:135], v[134:135], s[44:45]
    v_pk_mul_f32 v[136:137], v[136:137], s[44:45]
    v_pk_mul_f32 v[138:139], v[138:139], s[44:45]
    v_cvt_pk_bf16_f32 v40, v132, v133
    v_cvt_pk_bf16_f32 v41, v134, v135
    v_cvt_pk_bf16_f32 v42, v136, v137
    v_cvt_pk_bf16_f32 v43, v138, v139
    s_waitcnt lgkmcnt(8)
    v_lshlrev_b32 v124, 16, v44
    v_and_b32 v125, 0xffff0000, v44
    v_lshlrev_b32 v126, 16, v45
    v_and_b32 v127, 0xffff0000, v45
    v_lshlrev_b32 v128, 16, v46
    v_and_b32 v129, 0xffff0000, v46
    v_lshlrev_b32 v130, 16, v47
    v_and_b32 v131, 0xffff0000, v47
    v_pk_mul_f32 v[124:125], v[124:125], s[44:45]
    v_pk_mul_f32 v[126:127], v[126:127], s[44:45]
    v_pk_mul_f32 v[128:129], v[128:129], s[44:45]
    v_pk_mul_f32 v[130:131], v[130:131], s[44:45]
    v_cvt_pk_bf16_f32 v44, v124, v125
    v_cvt_pk_bf16_f32 v45, v126, v127
    v_cvt_pk_bf16_f32 v46, v128, v129
    v_cvt_pk_bf16_f32 v47, v130, v131
    s_waitcnt lgkmcnt(7)
    v_lshlrev_b32 v132, 16, v48
    v_and_b32 v133, 0xffff0000, v48
    v_lshlrev_b32 v134, 16, v49
    v_and_b32 v135, 0xffff0000, v49
    v_lshlrev_b32 v136, 16, v50
    v_and_b32 v137, 0xffff0000, v50
    v_lshlrev_b32 v138, 16, v51
    v_and_b32 v139, 0xffff0000, v51
    v_pk_mul_f32 v[132:133], v[132:133], s[44:45]
    v_pk_mul_f32 v[134:135], v[134:135], s[44:45]
    v_pk_mul_f32 v[136:137], v[136:137], s[44:45]
    v_pk_mul_f32 v[138:139], v[138:139], s[44:45]
    v_cvt_pk_bf16_f32 v48, v132, v133
    v_cvt_pk_bf16_f32 v49, v134, v135
    v_cvt_pk_bf16_f32 v50, v136, v137
    v_cvt_pk_bf16_f32 v51, v138, v139
    s_waitcnt lgkmcnt(6)
    v_lshlrev_b32 v124, 16, v52
    v_and_b32 v125, 0xffff0000, v52
    v_lshlrev_b32 v126, 16, v53
    v_and_b32 v127, 0xffff0000, v53
    v_lshlrev_b32 v128, 16, v54
    v_and_b32 v129, 0xffff0000, v54
    v_lshlrev_b32 v130, 16, v55
    v_and_b32 v131, 0xffff0000, v55
    v_pk_mul_f32 v[124:125], v[124:125], s[44:45]
    v_pk_mul_f32 v[126:127], v[126:127], s[44:45]
    v_pk_mul_f32 v[128:129], v[128:129], s[44:45]
    v_pk_mul_f32 v[130:131], v[130:131], s[44:45]
    v_cvt_pk_bf16_f32 v52, v124, v125
    v_cvt_pk_bf16_f32 v53, v126, v127
    v_cvt_pk_bf16_f32 v54, v128, v129
    v_cvt_pk_bf16_f32 v55, v130, v131
    s_waitcnt lgkmcnt(5)
    v_lshlrev_b32 v132, 16, v56
    v_and_b32 v133, 0xffff0000, v56
    v_lshlrev_b32 v134, 16, v57
    v_and_b32 v135, 0xffff0000, v57
    v_lshlrev_b32 v136, 16, v58
    v_and_b32 v137, 0xffff0000, v58
    v_lshlrev_b32 v138, 16, v59
    v_and_b32 v139, 0xffff0000, v59
    v_pk_mul_f32 v[132:133], v[132:133], s[44:45]
    v_pk_mul_f32 v[134:135], v[134:135], s[44:45]
    v_pk_mul_f32 v[136:137], v[136:137], s[44:45]
    v_pk_mul_f32 v[138:139], v[138:139], s[44:45]
    v_cvt_pk_bf16_f32 v56, v132, v133
    v_cvt_pk_bf16_f32 v57, v134, v135
    v_cvt_pk_bf16_f32 v58, v136, v137
    v_cvt_pk_bf16_f32 v59, v138, v139
    ds_read_b32 v5, v6 offset:16
L_mainA:
    s_waitcnt lgkmcnt(5)
    v_mfma_f32_16x16x32_bf16 v[124:127], v[220:223], v[28:31], v[8:11]
    s_waitcnt lgkmcnt(4)
    ds_read_b128 v[240:243], v1 offset:4352
    ds_read_b128 v[244:247], v1 offset:4608
    v_mfma_f32_16x16x32_bf16 v[124:127], v[224:227], v[32:35], v[124:127]
    s_waitcnt lgkmcnt(2)
    ds_read_b128 v[248:251], v1 offset:4864
    v_cmp_ne_u32 vcc, 0, v5
    v_mfma_f32_16x16x32_bf16 v[124:127], v[228:231], v[36:39], v[124:127]
    s_mov_b32 m0, s47
    s_mov_b64 exec, 1
    buffer_load_dword v66, s[12:15], s39 offen lds
    s_mov_b64 exec, -1
    v_mfma_f32_16x16x32_bf16 v[124:127], v[232:235], v[40:43], v[124:127]
    v_mfma_f32_16x16x32_bf16 v[128:131], v[220:223], v[44:47], v[12:15]
    s_cbranch_vccnz L_spin1
L_back1:
    ds_read_b128 v[252:255], v1 offset:8192
    ds_read_b128 v[220:223], v1 offset:8448
    v_mfma_f32_16x16x32_bf16 v[128:131], v[224:227], v[48:51], v[128:131]
    ds_read_b128 v[224:227], v1 offset:8704
    v_mfma_f32_16x16x32_bf16 v[128:131], v[228:231], v[52:55], v[128:131]
    s_nop 0
    v_exp_f32 v124, v124
    v_mfma_f32_16x16x32_bf16 v[128:131], v[232:235], v[56:59], v[128:131]
    ds_read_b128 v[228:231], v1 offset:8960
    ds_read_b32 v5, v6 offset:48
    v_mfma_f32_16x16x32_bf16 v[132:135], v[236:239], v[28:31], v[8:11]
    s_waitcnt lgkmcnt(7)
    v_exp_f32 v125, v125
    v_mfma_f32_16x16x32_bf16 v[132:135], v[240:243], v[32:35], v[132:135]
    s_waitcnt lgkmcnt(6)
    ds_read_b128 v[232:235], v1 offset:12288
    v_cvt_pk_bf16_f32 v156, v124, v125
    v_mfma_f32_16x16x32_bf16 v[132:135], v[244:247], v[36:39], v[132:135]
    s_waitcnt lgkmcnt(6)
    v_exp_f32 v126, v126
    v_mfma_f32_16x16x32_bf16 v[132:135], v[248:251], v[40:43], v[132:135]
    v_exp_f32 v127, v127
    v_mfma_f32_16x16x32_bf16 v[136:139], v[236:239], v[44:47], v[12:15]
    ds_read_b128 v[236:239], v1 offset:12544
    v_cvt_pk_bf16_f32 v157, v126, v127
    v_mfma_f32_16x16x32_bf16 v[136:139], v[240:243], v[48:51], v[136:139]
    v_exp_f32 v128, v128
    v_mfma_f32_16x16x32_bf16 v[136:139], v[244:247], v[52:55], v[136:139]
    ds_read_b128 v[240:243], v1 offset:12800
    ds_read_b128 v[244:247], v1 offset:13056
    v_mfma_f32_16x16x32_bf16 v[136:139], v[248:251], v[56:59], v[136:139]
    s_waitcnt lgkmcnt(8)
    v_exp_f32 v129, v129
    v_mfma_f32_16x16x32_bf16 v[140:143], v[252:255], v[28:31], v[8:11]
    s_waitcnt lgkmcnt(4)
    v_cmp_ne_u32 vcc, 0, v5
    v_mfma_f32_16x16x32_bf16 v[140:143], v[220:223], v[32:35], v[140:143]
    v_exp_f32 v130, v130
    v_mfma_f32_16x16x32_bf16 v[140:143], v[224:227], v[36:39], v[140:143]
    v_cvt_pk_bf16_f32 v160, v128, v129
    v_mfma_f32_16x16x32_bf16 v[140:143], v[228:231], v[40:43], v[140:143]
    s_cbranch_vccnz L_spin3
L_back3:
    ds_read_b32 v5, v6 offset:64
    ds_read_b128 v[248:251], v1 offset:16384
    v_mfma_f32_16x16x32_bf16 v[144:147], v[252:255], v[44:47], v[12:15]
    v_exp_f32 v131, v131
    v_mfma_f32_16x16x32_bf16 v[144:147], v[220:223], v[48:51], v[144:147]
    ds_read_b128 v[252:255], v1 offset:16640
    v_cvt_pk_bf16_f32 v161, v130, v131
    v_mfma_f32_16x16x32_bf16 v[144:147], v[224:227], v[52:55], v[144:147]
    v_exp_f32 v132, v132
    v_mfma_f32_16x16x32_bf16 v[144:147], v[228:231], v[56:59], v[144:147]
    s_waitcnt lgkmcnt(6)
    v_exp_f32 v133, v133
    v_mfma_f32_16x16x32_bf16 v[148:151], v[232:235], v[28:31], v[8:11]
    s_waitcnt lgkmcnt(2)
    ds_read_b128 v[220:223], v1 offset:16896
    v_cmp_ne_u32 vcc, 0, v5
    v_mfma_f32_16x16x32_bf16 v[148:151], v[236:239], v[32:35], v[148:151]
    ds_read_b128 v[224:227], v1 offset:17152
    v_cvt_pk_bf16_f32 v158, v132, v133
    v_exp_f32 v134, v134
    v_mfma_f32_16x16x32_bf16 v[148:151], v[240:243], v[36:39], v[148:151]
    v_exp_f32 v135, v135
    v_mfma_f32_16x16x32_bf16 v[148:151], v[244:247], v[40:43], v[148:151]
    s_cbranch_vccnz L_spin4
L_back4:
    v_cvt_pk_bf16_f32 v159, v134, v135
    v_exp_f32 v136, v136
    v_mfma_f32_16x16x32_bf16 v[152:155], v[232:235], v[44:47], v[12:15]
    v_exp_f32 v137, v137
    v_mfma_f32_16x16x32_bf16 v[152:155], v[236:239], v[48:51], v[152:155]
    v_cvt_pk_bf16_f32 v162, v136, v137
    v_exp_f32 v138, v138
    v_mfma_f32_16x16x32_bf16 v[152:155], v[240:243], v[52:55], v[152:155]
    ds_read_b64_tr_b16 v[228:229], v2 offset:0
    ds_read_b64_tr_b16 v[230:231], v2 offset:4128
    v_mfma_f32_16x16x32_bf16 v[152:155], v[244:247], v[56:59], v[152:155]
    s_waitcnt lgkmcnt(5)
    v_exp_f32 v139, v139
    v_mfma_f32_16x16x32_bf16 v[124:127], v[248:251], v[28:31], v[8:11]
    s_waitcnt lgkmcnt(4)
    ds_read_b64_tr_b16 v[232:233], v2 offset:8
    v_cvt_pk_bf16_f32 v163, v138, v139
    v_mfma_f32_16x16x32_bf16 v[124:127], v[252:255], v[32:35], v[124:127]
    s_waitcnt lgkmcnt(4)
    v_exp_f32 v140, v140
    v_mfma_f32_16x16x32_bf16 v[124:127], v[220:223], v[36:39], v[124:127]
    s_waitcnt lgkmcnt(3)
    ds_read_b64_tr_b16 v[234:235], v2 offset:4136
    ds_read_b128 v[236:239], v1 offset:20480
    v_mfma_f32_16x16x32_bf16 v[124:127], v[224:227], v[40:43], v[124:127]
    v_exp_f32 v141, v141
    v_mfma_f32_16x16x32_bf16 v[128:131], v[248:251], v[44:47], v[12:15]
    ds_read_b128 v[240:243], v1 offset:20736
    v_cvt_pk_bf16_f32 v164, v140, v141
    v_mfma_f32_16x16x32_bf16 v[128:131], v[252:255], v[48:51], v[128:131]
    v_exp_f32 v142, v142
    v_mfma_f32_16x16x32_bf16 v[128:131], v[220:223], v[52:55], v[128:131]
    ds_read_b128 v[244:247], v1 offset:20992
    ds_read_b128 v[248:251], v1 offset:21248
    v_mfma_f32_16x16x32_bf16 v[128:131], v[224:227], v[56:59], v[128:131]
    s_waitcnt lgkmcnt(6)
    v_exp_f32 v143, v143
    v_mfma_f32_16x16x32_bf16 v[60:63], v[228:231], v[156:159], 0
    ds_read_b128 v[252:255], v1 offset:24576
    v_cvt_pk_bf16_f32 v165, v142, v143
    v_mfma_f32_16x16x32_bf16 v[64:67], v[228:231], v[160:163], 0
    v_exp_f32 v144, v144
    v_mfma_f32_16x16x32_bf16 v[20:23], v[16:19], v[156:159], 0
    ds_read_b128 v[220:223], v1 offset:24832
    ds_read_b128 v[224:227], v1 offset:25088
    v_mfma_f32_16x16x32_bf16 v[24:27], v[16:19], v[160:163], 0
    s_waitcnt lgkmcnt(7)
    v_exp_f32 v145, v145
    v_mfma_f32_16x16x32_bf16 v[68:71], v[232:235], v[156:159], 0
    ds_read_b128 v[228:231], v1 offset:25344
    v_cvt_pk_bf16_f32 v168, v144, v145
    v_mfma_f32_16x16x32_bf16 v[72:75], v[232:235], v[160:163], 0
    s_waitcnt lgkmcnt(7)
    v_exp_f32 v146, v146
    v_mfma_f32_16x16x32_bf16 v[132:135], v[236:239], v[28:31], v[8:11]
    s_waitcnt lgkmcnt(6)
    v_exp_f32 v147, v147
    v_mfma_f32_16x16x32_bf16 v[132:135], v[240:243], v[32:35], v[132:135]
    s_waitcnt lgkmcnt(5)
    v_cvt_pk_bf16_f32 v169, v146, v147
    v_exp_f32 v148, v148
    v_mfma_f32_16x16x32_bf16 v[132:135], v[244:247], v[36:39], v[132:135]
    s_waitcnt lgkmcnt(4)
    v_exp_f32 v149, v149
    v_mfma_f32_16x16x32_bf16 v[132:135], v[248:251], v[40:43], v[132:135]
    v_cvt_pk_bf16_f32 v166, v148, v149
    v_exp_f32 v150, v150
    v_mfma_f32_16x16x32_bf16 v[136:139], v[236:239], v[44:47], v[12:15]
    v_exp_f32 v151, v151
    v_mfma_f32_16x16x32_bf16 v[136:139], v[240:243], v[48:51], v[136:139]
    v_cvt_pk_bf16_f32 v167, v150, v151
    v_exp_f32 v152, v152
    v_mfma_f32_16x16x32_bf16 v[136:139], v[244:247], v[52:55], v[136:139]
    ds_read_b64_tr_b16 v[232:233], v2 offset:8256
    ds_read_b64_tr_b16 v[234:235], v2 offset:12384
    v_exp_f32 v153, v153
    v_mfma_f32_16x16x32_bf16 v[136:139], v[248:251], v[56:59], v[136:139]
    s_waitcnt lgkmcnt(5)
    v_cvt_pk_bf16_f32 v170, v152, v153
    v_exp_f32 v154, v154
    v_mfma_f32_16x16x32_bf16 v[140:143], v[252:255], v[28:31], v[8:11]
    s_waitcnt lgkmcnt(4)
    v_exp_f32 v155, v155
    v_mfma_f32_16x16x32_bf16 v[140:143], v[220:223], v[32:35], v[140:143]
    s_waitcnt lgkmcnt(3)
    v_cvt_pk_bf16_f32 v171, v154, v155
    v_exp_f32 v124, v124
    v_mfma_f32_16x16x32_bf16 v[140:143], v[224:227], v[36:39], v[140:143]
    s_waitcnt lgkmcnt(2)
    ds_read_b64_tr_b16 v[236:237], v2 offset:8264
    ds_read_b64_tr_b16 v[238:239], v2 offset:12392
    ds_read_b32 v5, v6 offset:80
    v_mfma_f32_16x16x32_bf16 v[140:143], v[228:231], v[40:43], v[140:143]
    v_exp_f32 v125, v125
    v_mfma_f32_16x16x32_bf16 v[144:147], v[252:255], v[44:47], v[12:15]
    ds_read_b128 v[240:243], v1 offset:28672
    v_cvt_pk_bf16_f32 v172, v124, v125
    v_mfma_f32_16x16x32_bf16 v[144:147], v[220:223], v[48:51], v[144:147]
    ds_read_b128 v[244:247], v1 offset:28928
    ds_read_b128 v[248:251], v1 offset:29184
    v_mfma_f32_16x16x32_bf16 v[144:147], v[224:227], v[52:55], v[144:147]
    s_waitcnt lgkmcnt(3)
    ds_read_b128 v[252:255], v1 offset:29440
    v_cmp_ne_u32 vcc, 0, v5
    v_mfma_f32_16x16x32_bf16 v[144:147], v[228:231], v[56:59], v[144:147]
    v_exp_f32 v126, v126
    v_mfma_f32_16x16x32_bf16 v[60:63], v[232:235], v[164:167], v[60:63]
    v_exp_f32 v127, v127
    v_mfma_f32_16x16x32_bf16 v[64:67], v[232:235], v[168:171], v[64:67]
    s_cbranch_vccnz L_spin5
L_back5:
    v_cvt_pk_bf16_f32 v173, v126, v127
    v_exp_f32 v128, v128
    v_mfma_f32_16x16x32_bf16 v[20:23], v[16:19], v[164:167], v[20:23]
    ds_read_b128 v[220:223], v1 offset:32768
    ds_read_b128 v[224:227], v1 offset:33024
    v_mfma_f32_16x16x32_bf16 v[24:27], v[16:19], v[168:171], v[24:27]
    v_exp_f32 v129, v129
    v_mfma_f32_16x16x32_bf16 v[68:71], v[236:239], v[164:167], v[68:71]
    ds_read_b128 v[228:231], v1 offset:33280
    v_cvt_pk_bf16_f32 v176, v128, v129
    v_mfma_f32_16x16x32_bf16 v[72:75], v[236:239], v[168:171], v[72:75]
    s_waitcnt lgkmcnt(6)
    v_exp_f32 v130, v130
    v_mfma_f32_16x16x32_bf16 v[148:151], v[240:243], v[28:31], v[8:11]
    s_waitcnt lgkmcnt(5)
    v_exp_f32 v131, v131
    v_mfma_f32_16x16x32_bf16 v[148:151], v[244:247], v[32:35], v[148:151]
    s_waitcnt lgkmcnt(4)
    ds_read_b128 v[232:235], v1 offset:33536
    v_cvt_pk_bf16_f32 v177, v130, v131
    v_exp_f32 v132, v132
    v_mfma_f32_16x16x32_bf16 v[148:151], v[248:251], v[36:39], v[148:151]
    s_waitcnt lgkmcnt(4)
    v_exp_f32 v133, v133
    v_mfma_f32_16x16x32_bf16 v[148:151], v[252:255], v[40:43], v[148:151]
    v_cvt_pk_bf16_f32 v174, v132, v133
    v_exp_f32 v134, v134
    v_mfma_f32_16x16x32_bf16 v[152:155], v[240:243], v[44:47], v[12:15]
    v_exp_f32 v135, v135
    v_mfma_f32_16x16x32_bf16 v[152:155], v[244:247], v[48:51], v[152:155]
    v_cvt_pk_bf16_f32 v175, v134, v135
    v_exp_f32 v136, v136
    v_mfma_f32_16x16x32_bf16 v[152:155], v[248:251], v[52:55], v[152:155]
    ds_read_b64_tr_b16 v[236:237], v2 offset:16512
    ds_read_b64_tr_b16 v[238:239], v2 offset:20640
    v_exp_f32 v137, v137
    v_mfma_f32_16x16x32_bf16 v[152:155], v[252:255], v[56:59], v[152:155]
    s_waitcnt lgkmcnt(5)
    v_cvt_pk_bf16_f32 v178, v136, v137
    v_exp_f32 v138, v138
    v_mfma_f32_16x16x32_bf16 v[124:127], v[220:223], v[28:31], v[8:11]
    s_waitcnt lgkmcnt(4)
    v_exp_f32 v139, v139
    v_mfma_f32_16x16x32_bf16 v[124:127], v[224:227], v[32:35], v[124:127]
    s_waitcnt lgkmcnt(3)
    v_cvt_pk_bf16_f32 v179, v138, v139
    v_exp_f32 v140, v140
    v_mfma_f32_16x16x32_bf16 v[124:127], v[228:231], v[36:39], v[124:127]
    s_waitcnt lgkmcnt(2)
    ds_read_b64_tr_b16 v[240:241], v2 offset:16520
    ds_read_b64_tr_b16 v[242:243], v2 offset:20648
    v_mfma_f32_16x16x32_bf16 v[124:127], v[232:235], v[40:43], v[124:127]
    v_exp_f32 v141, v141
    v_mfma_f32_16x16x32_bf16 v[128:131], v[220:223], v[44:47], v[12:15]
    ds_read_b128 v[244:247], v1 offset:36864
    v_exp_f32 v142, v142
    v_mfma_f32_16x16x32_bf16 v[128:131], v[224:227], v[48:51], v[128:131]
    ds_read_b128 v[248:251], v1 offset:37120
    v_cvt_pk_bf16_f32 v180, v140, v141
    v_mfma_f32_16x16x32_bf16 v[128:131], v[228:231], v[52:55], v[128:131]
    ds_read_b128 v[252:255], v1 offset:37376
    ds_read_b128 v[220:223], v1 offset:37632
    v_mfma_f32_16x16x32_bf16 v[128:131], v[232:235], v[56:59], v[128:131]
    s_waitcnt lgkmcnt(6)
    v_exp_f32 v143, v143
    v_mfma_f32_16x16x32_bf16 v[60:63], v[236:239], v[172:175], v[60:63]
    ds_read_b32 v5, v6 offset:96
    v_cvt_pk_bf16_f32 v181, v142, v143
    v_mfma_f32_16x16x32_bf16 v[64:67], v[236:239], v[176:179], v[64:67]
    v_exp_f32 v144, v144
    v_mfma_f32_16x16x32_bf16 v[20:23], v[16:19], v[172:175], v[20:23]
    ds_read_b128 v[224:227], v1 offset:40960
    ds_read_b128 v[228:231], v1 offset:41216
    v_mfma_f32_16x16x32_bf16 v[24:27], v[16:19], v[176:179], v[24:27]
    s_waitcnt lgkmcnt(7)
    v_exp_f32 v145, v145
    v_mfma_f32_16x16x32_bf16 v[68:71], v[240:243], v[172:175], v[68:71]
    ds_read_b128 v[232:235], v1 offset:41472
    v_cvt_pk_bf16_f32 v184, v144, v145
    v_mfma_f32_16x16x32_bf16 v[72:75], v[240:243], v[176:179], v[72:75]
    s_waitcnt lgkmcnt(7)
    v_exp_f32 v146, v146
    v_mfma_f32_16x16x32_bf16 v[132:135], v[244:247], v[28:31], v[8:11]
    s_waitcnt lgkmcnt(3)
    ds_read_b128 v[236:239], v1 offset:41728
    v_cmp_ne_u32 vcc, 0, v5
    v_mfma_f32_16x16x32_bf16 v[132:135], v[248:251], v[32:35], v[132:135]
    v_exp_f32 v147, v147
    v_mfma_f32_16x16x32_bf16 v[132:135], v[252:255], v[36:39], v[132:135]
    v_cvt_pk_bf16_f32 v185, v146, v147
    v_exp_f32 v148, v148
    v_mfma_f32_16x16x32_bf16 v[132:135], v[220:223], v[40:43], v[132:135]
    s_cbranch_vccnz L_spin6
L_back6:
    v_exp_f32 v149, v149
    v_mfma_f32_16x16x32_bf16 v[136:139], v[244:247], v[44:47], v[12:15]
    v_cvt_pk_bf16_f32 v182, v148, v149
    v_exp_f32 v150, v150
    v_mfma_f32_16x16x32_bf16 v[136:139], v[248:251], v[48:51], v[136:139]
    v_exp_f32 v151, v151
    v_mfma_f32_16x16x32_bf16 v[136:139], v[252:255], v[52:55], v[136:139]
    ds_read_b64_tr_b16 v[240:241], v2 offset:24768
    ds_read_b64_tr_b16 v[242:243], v2 offset:28896
    v_exp_f32 v152, v152
    v_mfma_f32_16x16x32_bf16 v[136:139], v[220:223], v[56:59], v[136:139]
    s_waitcnt lgkmcnt(5)
    v_cvt_pk_bf16_f32 v183, v150, v151
    v_exp_f32 v153, v153
    v_mfma_f32_16x16x32_bf16 v[140:143], v[224:227], v[28:31], v[8:11]
    s_waitcnt lgkmcnt(4)
    v_cvt_pk_bf16_f32 v186, v152, v153
    v_exp_f32 v154, v154
    v_mfma_f32_16x16x32_bf16 v[140:143], v[228:231], v[32:35], v[140:143]
    s_waitcnt lgkmcnt(3)
    v_exp_f32 v155, v155
    v_mfma_f32_16x16x32_bf16 v[140:143], v[232:235], v[36:39], v[140:143]
    s_waitcnt lgkmcnt(2)
    ds_read_b64_tr_b16 v[244:245], v2 offset:24776
    ds_read_b64_tr_b16 v[246:247], v2 offset:28904
    v_exp_f32 v124, v124
    v_mfma_f32_16x16x32_bf16 v[140:143], v[236:239], v[40:43], v[140:143]
    v_cvt_pk_bf16_f32 v187, v154, v155
    v_exp_f32 v125, v125
    v_mfma_f32_16x16x32_bf16 v[144:147], v[224:227], v[44:47], v[12:15]
    ds_read_b128 v[248:251], v1 offset:45056
    v_cvt_pk_bf16_f32 v188, v124, v125
    v_mfma_f32_16x16x32_bf16 v[144:147], v[228:231], v[48:51], v[144:147]
    ds_read_b128 v[252:255], v1 offset:45312
    ds_read_b128 v[220:223], v1 offset:45568
    v_mfma_f32_16x16x32_bf16 v[144:147], v[232:235], v[52:55], v[144:147]
    v_exp_f32 v126, v126
    v_mfma_f32_16x16x32_bf16 v[144:147], v[236:239], v[56:59], v[144:147]
    s_waitcnt lgkmcnt(5)
    ds_read_b128 v[224:227], v1 offset:45824
    ds_read_b128 v[228:231], v1 offset:49152
    v_mfma_f32_16x16x32_bf16 v[60:63], v[240:243], v[180:183], v[60:63]
    v_exp_f32 v127, v127
    v_mfma_f32_16x16x32_bf16 v[64:67], v[240:243], v[184:187], v[64:67]
    ds_read_b128 v[232:235], v1 offset:49408
    v_cvt_pk_bf16_f32 v189, v126, v127
    v_mfma_f32_16x16x32_bf16 v[20:23], v[16:19], v[180:183], v[20:23]
    v_exp_f32 v128, v128
    v_mfma_f32_16x16x32_bf16 v[24:27], v[16:19], v[184:187], v[24:27]
    s_waitcnt lgkmcnt(6)
    ds_read_b128 v[236:239], v1 offset:49664
    ds_read_b128 v[240:243], v1 offset:49920
    v_mfma_f32_16x16x32_bf16 v[68:71], v[244:247], v[180:183], v[68:71]
    v_exp_f32 v129, v129
    v_mfma_f32_16x16x32_bf16 v[72:75], v[244:247], v[184:187], v[72:75]
    s_waitcnt lgkmcnt(7)
    v_cvt_pk_bf16_f32 v192, v128, v129
    v_exp_f32 v130, v130
    v_mfma_f32_16x16x32_bf16 v[148:151], v[248:251], v[28:31], v[8:11]
    s_waitcnt lgkmcnt(6)
    v_exp_f32 v131, v131
    v_mfma_f32_16x16x32_bf16 v[148:151], v[252:255], v[32:35], v[148:151]
    s_waitcnt lgkmcnt(5)
    v_cvt_pk_bf16_f32 v193, v130, v131
    v_exp_f32 v132, v132
    v_mfma_f32_16x16x32_bf16 v[148:151], v[220:223], v[36:39], v[148:151]
    s_waitcnt lgkmcnt(4)
    v_exp_f32 v133, v133
    v_mfma_f32_16x16x32_bf16 v[148:151], v[224:227], v[40:43], v[148:151]
    v_cvt_pk_bf16_f32 v190, v132, v133
    v_exp_f32 v134, v134
    v_mfma_f32_16x16x32_bf16 v[152:155], v[248:251], v[44:47], v[12:15]
    v_exp_f32 v135, v135
    v_mfma_f32_16x16x32_bf16 v[152:155], v[252:255], v[48:51], v[152:155]
    v_cvt_pk_bf16_f32 v191, v134, v135
    v_exp_f32 v136, v136
    v_mfma_f32_16x16x32_bf16 v[152:155], v[220:223], v[52:55], v[152:155]
    ds_read_b64_tr_b16 v[244:245], v2 offset:33024
    ds_read_b64_tr_b16 v[246:247], v2 offset:37152
    v_exp_f32 v137, v137
    v_mfma_f32_16x16x32_bf16 v[152:155], v[224:227], v[56:59], v[152:155]
    s_waitcnt lgkmcnt(5)
    v_cvt_pk_bf16_f32 v194, v136, v137
    v_exp_f32 v138, v138
    v_mfma_f32_16x16x32_bf16 v[124:127], v[228:231], v[28:31], v[8:11]
    s_waitcnt lgkmcnt(4)
    v_exp_f32 v139, v139
    v_mfma_f32_16x16x32_bf16 v[124:127], v[232:235], v[32:35], v[124:127]
    s_waitcnt lgkmcnt(3)
    v_cvt_pk_bf16_f32 v195, v138, v139
    v_exp_f32 v140, v140
    v_mfma_f32_16x16x32_bf16 v[124:127], v[236:239], v[36:39], v[124:127]
    s_waitcnt lgkmcnt(2)
    ds_read_b64_tr_b16 v[248:249], v2 offset:33032
    ds_read_b64_tr_b16 v[250:251], v2 offset:37160
    v_mfma_f32_16x16x32_bf16 v[124:127], v[240:243], v[40:43], v[124:127]
    v_exp_f32 v141, v141
    v_mfma_f32_16x16x32_bf16 v[128:131], v[228:231], v[44:47], v[12:15]
    ds_read_b128 v[252:255], v1 offset:53248
    v_cvt_pk_bf16_f32 v196, v140, v141
    v_exp_f32 v142, v142
    v_mfma_f32_16x16x32_bf16 v[128:131], v[232:235], v[48:51], v[128:131]
    ds_read_b128 v[220:223], v1 offset:53504
    v_exp_f32 v143, v143
    v_mfma_f32_16x16x32_bf16 v[128:131], v[236:239], v[52:55], v[128:131]
    ds_read_b128 v[224:227], v1 offset:53760
    v_cvt_pk_bf16_f32 v197, v142, v143
    v_exp_f32 v144, v144
    v_mfma_f32_16x16x32_bf16 v[128:131], v[240:243], v[56:59], v[128:131]
    s_waitcnt lgkmcnt(5)
    ds_read_b128 v[228:231], v1 offset:54016
    v_exp_f32 v145, v145
    v_mfma_f32_16x16x32_bf16 v[60:63], v[244:247], v[188:191], v[60:63]
    ds_read_b32 v5, v6 offset:112
    v_cvt_pk_bf16_f32 v200, v144, v145
    v_exp_f32 v146, v146
    v_mfma_f32_16x16x32_bf16 v[64:67], v[244:247], v[192:195], v[64:67]
    v_exp_f32 v147, v147
    v_mfma_f32_16x16x32_bf16 v[20:23], v[16:19], v[188:191], v[20:23]
    v_cvt_pk_bf16_f32 v201, v146, v147
    v_exp_f32 v148, v148
    v_mfma_f32_16x16x32_bf16 v[24:27], v[16:19], v[192:195], v[24:27]
    s_waitcnt lgkmcnt(5)
    v_exp_f32 v149, v149
    v_mfma_f32_16x16x32_bf16 v[68:71], v[248:251], v[188:191], v[68:71]
    ds_read_b128 v[232:235], v1 offset:57344
    v_cvt_pk_bf16_f32 v198, v148, v149
    v_exp_f32 v150, v150
    v_mfma_f32_16x16x32_bf16 v[72:75], v[248:251], v[192:195], v[72:75]
    s_waitcnt lgkmcnt(5)
    ds_read_b128 v[236:239], v1 offset:57600
    v_exp_f32 v151, v151
    v_mfma_f32_16x16x32_bf16 v[132:135], v[252:255], v[28:31], v[8:11]
    s_waitcnt lgkmcnt(2)
    ds_read_b128 v[240:243], v1 offset:57856
    v_cmp_ne_u32 vcc, 0, v5
    v_mfma_f32_16x16x32_bf16 v[132:135], v[220:223], v[32:35], v[132:135]
    ds_read_b128 v[244:247], v1 offset:58112
    v_cvt_pk_bf16_f32 v199, v150, v151
    v_exp_f32 v152, v152
    v_mfma_f32_16x16x32_bf16 v[132:135], v[224:227], v[36:39], v[132:135]
    v_exp_f32 v153, v153
    v_mfma_f32_16x16x32_bf16 v[132:135], v[228:231], v[40:43], v[132:135]
    s_cbranch_vccnz L_spin7
L_back7:
    v_cvt_pk_bf16_f32 v202, v152, v153
    v_exp_f32 v154, v154
    v_mfma_f32_16x16x32_bf16 v[136:139], v[252:255], v[44:47], v[12:15]
    v_exp_f32 v155, v155
    v_mfma_f32_16x16x32_bf16 v[136:139], v[220:223], v[48:51], v[136:139]
    v_cvt_pk_bf16_f32 v203, v154, v155
    v_exp_f32 v124, v124
    v_mfma_f32_16x16x32_bf16 v[136:139], v[224:227], v[52:55], v[136:139]
    ds_read_b64_tr_b16 v[248:249], v2 offset:41280
    ds_read_b64_tr_b16 v[250:251], v2 offset:45408
    v_exp_f32 v125, v125
    v_mfma_f32_16x16x32_bf16 v[136:139], v[228:231], v[56:59], v[136:139]
    s_waitcnt lgkmcnt(5)
    v_cvt_pk_bf16_f32 v204, v124, v125
    v_exp_f32 v126, v126
    v_mfma_f32_16x16x32_bf16 v[140:143], v[232:235], v[28:31], v[8:11]
    s_waitcnt lgkmcnt(4)
    v_exp_f32 v127, v127
    v_mfma_f32_16x16x32_bf16 v[140:143], v[236:239], v[32:35], v[140:143]
    s_waitcnt lgkmcnt(3)
    v_cvt_pk_bf16_f32 v205, v126, v127
    v_exp_f32 v128, v128
    v_mfma_f32_16x16x32_bf16 v[140:143], v[240:243], v[36:39], v[140:143]
    s_waitcnt lgkmcnt(2)
    ds_read_b64_tr_b16 v[252:253], v2 offset:41288
    ds_read_b64_tr_b16 v[254:255], v2 offset:45416
    v_exp_f32 v129, v129
    v_mfma_f32_16x16x32_bf16 v[140:143], v[244:247], v[40:43], v[140:143]
    v_cvt_pk_bf16_f32 v208, v128, v129
    v_exp_f32 v130, v130
    v_mfma_f32_16x16x32_bf16 v[144:147], v[232:235], v[44:47], v[12:15]
    ds_read_b128 v[220:223], v1 offset:61440
    v_exp_f32 v131, v131
    v_mfma_f32_16x16x32_bf16 v[144:147], v[236:239], v[48:51], v[144:147]
    ds_read_b128 v[224:227], v1 offset:61696
    v_cvt_pk_bf16_f32 v209, v130, v131
    v_exp_f32 v132, v132
    v_mfma_f32_16x16x32_bf16 v[144:147], v[240:243], v[52:55], v[144:147]
    ds_read_b128 v[228:231], v1 offset:61952
    v_exp_f32 v133, v133
    v_mfma_f32_16x16x32_bf16 v[144:147], v[244:247], v[56:59], v[144:147]
    s_waitcnt lgkmcnt(5)
    ds_read_b128 v[232:235], v1 offset:62208
    v_cvt_pk_bf16_f32 v206, v132, v133
    v_exp_f32 v134, v134
    v_mfma_f32_16x16x32_bf16 v[60:63], v[248:251], v[196:199], v[60:63]
    v_exp_f32 v135, v135
    v_mfma_f32_16x16x32_bf16 v[64:67], v[248:251], v[200:203], v[64:67]
    v_cvt_pk_bf16_f32 v207, v134, v135
    v_exp_f32 v136, v136
    v_mfma_f32_16x16x32_bf16 v[20:23], v[16:19], v[196:199], v[20:23]
    v_exp_f32 v137, v137
    v_mfma_f32_16x16x32_bf16 v[24:27], v[16:19], v[200:203], v[24:27]
    s_waitcnt lgkmcnt(4)
    v_cvt_pk_bf16_f32 v210, v136, v137
    v_exp_f32 v138, v138
    v_mfma_f32_16x16x32_bf16 v[68:71], v[252:255], v[196:199], v[68:71]
    ds_read_b64_tr_b16 v[236:237], v2 offset:49536
    ds_read_b64_tr_b16 v[238:239], v2 offset:53664
    v_exp_f32 v139, v139
    v_mfma_f32_16x16x32_bf16 v[72:75], v[252:255], v[200:203], v[72:75]
    s_waitcnt lgkmcnt(5)
    v_cvt_pk_bf16_f32 v211, v138, v139
    v_exp_f32 v140, v140
    v_mfma_f32_16x16x32_bf16 v[148:151], v[220:223], v[28:31], v[8:11]
    s_waitcnt lgkmcnt(4)
    v_exp_f32 v141, v141
    v_mfma_f32_16x16x32_bf16 v[148:151], v[224:227], v[32:35], v[148:151]
    s_waitcnt lgkmcnt(3)
    v_cvt_pk_bf16_f32 v212, v140, v141
    v_exp_f32 v142, v142
    v_mfma_f32_16x16x32_bf16 v[148:151], v[228:231], v[36:39], v[148:151]
    s_waitcnt lgkmcnt(2)
    ds_read_b64_tr_b16 v[240:241], v2 offset:49544
    ds_read_b64_tr_b16 v[242:243], v2 offset:53672
    v_exp_f32 v143, v143
    v_mfma_f32_16x16x32_bf16 v[148:151], v[232:235], v[40:43], v[148:151]
    v_cvt_pk_bf16_f32 v213, v142, v143
    v_exp_f32 v144, v144
    v_mfma_f32_16x16x32_bf16 v[152:155], v[220:223], v[44:47], v[12:15]
    ds_read_b64_tr_b16 v[244:245], v2 offset:256
    ds_read_b64_tr_b16 v[246:247], v2 offset:4384
    v_exp_f32 v145, v145
    v_mfma_f32_16x16x32_bf16 v[152:155], v[224:227], v[48:51], v[152:155]
    ds_read_b64_tr_b16 v[248:249], v2 offset:8512
    ds_read_b64_tr_b16 v[250:251], v2 offset:12640
    v_exp_f32 v146, v146
    v_mfma_f32_16x16x32_bf16 v[152:155], v[228:231], v[52:55], v[152:155]
    ds_read_b64_tr_b16 v[252:253], v2 offset:16768
    ds_read_b64_tr_b16 v[254:255], v2 offset:20896
    v_exp_f32 v147, v147
    v_mfma_f32_16x16x32_bf16 v[152:155], v[232:235], v[56:59], v[152:155]
    s_waitcnt lgkmcnt(8)
    ds_read_b64_tr_b16 v[220:221], v2 offset:25024
    ds_read_b64_tr_b16 v[222:223], v2 offset:29152
    v_exp_f32 v148, v148
    v_mfma_f32_16x16x32_bf16 v[60:63], v[236:239], v[204:207], v[60:63]
    v_cvt_pk_bf16_f32 v216, v144, v145
    v_exp_f32 v149, v149
    v_mfma_f32_16x16x32_bf16 v[64:67], v[236:239], v[208:211], v[64:67]
    v_cvt_pk_bf16_f32 v217, v146, v147
    v_exp_f32 v150, v150
    v_mfma_f32_16x16x32_bf16 v[20:23], v[16:19], v[204:207], v[20:23]
    v_cvt_pk_bf16_f32 v214, v148, v149
    v_exp_f32 v151, v151
    v_mfma_f32_16x16x32_bf16 v[24:27], v[16:19], v[208:211], v[24:27]
    s_waitcnt lgkmcnt(8)
    v_cvt_pk_bf16_f32 v215, v150, v151
    v_exp_f32 v152, v152
    v_mfma_f32_16x16x32_bf16 v[68:71], v[240:243], v[204:207], v[68:71]
    ds_read_b64_tr_b16 v[224:225], v2 offset:57792
    ds_read_b64_tr_b16 v[226:227], v2 offset:61920
    v_mfma_f32_16x16x32_bf16 v[72:75], v[240:243], v[208:211], v[72:75]
    s_waitcnt lgkmcnt(8)
    v_exp_f32 v153, v153
    v_mfma_f32_16x16x32_bf16 v[76:79], v[244:247], v[156:159], 0
    s_waitcnt lgkmcnt(6)
    ds_read_b64_tr_b16 v[228:229], v2 offset:57800
    v_cvt_pk_bf16_f32 v218, v152, v153
    v_mfma_f32_16x16x32_bf16 v[76:79], v[248:251], v[164:167], v[76:79]
    s_waitcnt lgkmcnt(5)
    v_exp_f32 v154, v154
    v_mfma_f32_16x16x32_bf16 v[76:79], v[252:255], v[172:175], v[76:79]
    s_waitcnt lgkmcnt(3)
    ds_read_b64_tr_b16 v[230:231], v2 offset:61928
    ds_read_b64_tr_b16 v[232:233], v2 offset:33280
    v_mfma_f32_16x16x32_bf16 v[76:79], v[220:223], v[180:183], v[76:79]
    v_exp_f32 v155, v155
    v_mfma_f32_16x16x32_bf16 v[80:83], v[244:247], v[160:163], 0
    ds_read_b64_tr_b16 v[234:235], v2 offset:37408
    v_cvt_pk_bf16_f32 v219, v154, v155
    v_mfma_f32_16x16x32_bf16 v[80:83], v[248:251], v[168:171], v[80:83]
    ds_read_b64_tr_b16 v[236:237], v2 offset:41536
    ds_read_b64_tr_b16 v[238:239], v2 offset:45664
    v_mfma_f32_16x16x32_bf16 v[80:83], v[252:255], v[176:179], v[80:83]
    ds_read_b64_tr_b16 v[240:241], v2 offset:49792
    ds_read_b64_tr_b16 v[242:243], v2 offset:53920
    v_mfma_f32_16x16x32_bf16 v[80:83], v[220:223], v[184:187], v[80:83]
    ds_read_b64_tr_b16 v[244:245], v2 offset:58048
    ds_read_b64_tr_b16 v[246:247], v2 offset:62176
    v_mfma_f32_16x16x32_bf16 v[20:23], v[16:19], v[212:215], v[20:23]
    ds_read_b64_tr_b16 v[248:249], v2 offset:264
    ds_read_b64_tr_b16 v[250:251], v2 offset:4392
    v_mfma_f32_16x16x32_bf16 v[24:27], v[16:19], v[216:219], v[24:27]
    s_waitcnt lgkmcnt(12)
    ds_read_b64_tr_b16 v[252:253], v2 offset:8520
    ds_read_b64_tr_b16 v[254:255], v2 offset:12648
    v_mfma_f32_16x16x32_bf16 v[60:63], v[224:227], v[212:215], v[60:63]
    ds_read_b64_tr_b16 v[220:221], v2 offset:16776
    ds_read_b64_tr_b16 v[222:223], v2 offset:20904
    v_mfma_f32_16x16x32_bf16 v[64:67], v[224:227], v[216:219], v[64:67]
    s_waitcnt lgkmcnt(14)
    ds_read_b64_tr_b16 v[224:225], v2 offset:25032
    ds_read_b64_tr_b16 v[226:227], v2 offset:29160
    v_mfma_f32_16x16x32_bf16 v[68:71], v[228:231], v[212:215], v[68:71]
    v_max_f32 v7, v20, v24
    v_min_f32 v0, v20, v24
    v_mfma_f32_16x16x32_bf16 v[72:75], v[228:231], v[216:219], v[72:75]
    s_waitcnt lgkmcnt(14)
    ds_read_b64_tr_b16 v[228:229], v2 offset:33288
    v_cmp_ngt_f32 s[42:43], s31, v7
    v_mfma_f32_16x16x32_bf16 v[76:79], v[232:235], v[188:191], v[76:79]
    s_waitcnt lgkmcnt(13)
    ds_read_b64_tr_b16 v[230:231], v2 offset:37416
    v_cmp_nlt_f32 s[48:49], s38, v0
    v_mfma_f32_16x16x32_bf16 v[76:79], v[236:239], v[196:199], v[76:79]
    s_waitcnt lgkmcnt(12)
    v_rcp_f32 v20, v20
    v_mfma_f32_16x16x32_bf16 v[76:79], v[240:243], v[204:207], v[76:79]
    s_waitcnt lgkmcnt(10)
    v_rcp_f32 v24, v24
    v_mfma_f32_16x16x32_bf16 v[76:79], v[244:247], v[212:215], v[76:79]
    s_or_b64 s[42:43], s[42:43], s[48:49]
    s_and_b64 s[42:43], s[42:43], s[32:33]
    s_cbranch_scc1 L_slow
    v_mfma_f32_16x16x32_bf16 v[80:83], v[232:235], v[192:195], v[80:83]
    ds_read_b64_tr_b16 v[232:233], v2 offset:41544
    v_mul_f32 v60, v60, v20
    v_mfma_f32_16x16x32_bf16 v[80:83], v[236:239], v[200:203], v[80:83]
    ds_read_b64_tr_b16 v[234:235], v2 offset:45672
    v_mul_f32 v61, v61, v20
    v_mfma_f32_16x16x32_bf16 v[80:83], v[240:243], v[208:211], v[80:83]
    ds_read_b64_tr_b16 v[236:237], v2 offset:49800
    v_mul_f32 v62, v62, v20
    v_mfma_f32_16x16x32_bf16 v[80:83], v[244:247], v[216:219], v[80:83]
    s_waitcnt lgkmcnt(11)
    ds_read_b64_tr_b16 v[238:239], v2 offset:53928
    v_mul_f32 v63, v63, v20
    v_mfma_f32_16x16x32_bf16 v[84:87], v[248:251], v[156:159], 0
    s_waitcnt lgkmcnt(10)
    ds_read_b64_tr_b16 v[240:241], v2 offset:58056
    v_cvt_pk_bf16_f32 v124, v60, v61
    v_mfma_f32_16x16x32_bf16 v[84:87], v[252:255], v[164:167], v[84:87]
    s_waitcnt lgkmcnt(9)
    ds_read_b64_tr_b16 v[242:243], v2 offset:62184
    v_cvt_pk_bf16_f32 v125, v62, v63
    v_mfma_f32_16x16x32_bf16 v[84:87], v[220:223], v[172:175], v[84:87]
    s_waitcnt lgkmcnt(8)
    ds_read_b64_tr_b16 v[244:245], v2 offset:512
    v_mul_f32 v64, v64, v24
    v_mfma_f32_16x16x32_bf16 v[84:87], v[224:227], v[180:183], v[84:87]
    ds_read_b64_tr_b16 v[246:247], v2 offset:4640
    v_mul_f32 v65, v65, v24
    v_mfma_f32_16x16x32_bf16 v[88:91], v[248:251], v[160:163], 0
    ds_read_b64_tr_b16 v[248:249], v2 offset:8768
    v_mul_f32 v66, v66, v24
    v_mfma_f32_16x16x32_bf16 v[88:91], v[252:255], v[168:171], v[88:91]
    ds_read_b64_tr_b16 v[250:251], v2 offset:12896
    v_mul_f32 v67, v67, v24
    v_mfma_f32_16x16x32_bf16 v[88:91], v[220:223], v[176:179], v[88:91]
    ds_read_b64_tr_b16 v[252:253], v2 offset:17024
    v_cvt_pk_bf16_f32 v128, v64, v65
    v_mfma_f32_16x16x32_bf16 v[88:91], v[224:227], v[184:187], v[88:91]
    s_waitcnt lgkmcnt(11)
    ds_read_b64_tr_b16 v[254:255], v2 offset:21152
    v_cvt_pk_bf16_f32 v129, v66, v67
    v_mfma_f32_16x16x32_bf16 v[84:87], v[228:231], v[188:191], v[84:87]
    s_waitcnt lgkmcnt(10)
    ds_read_b64_tr_b16 v[220:221], v2 offset:25280
    v_mul_f32 v68, v68, v20
    v_mfma_f32_16x16x32_bf16 v[84:87], v[232:235], v[196:199], v[84:87]
    s_waitcnt lgkmcnt(9)
    ds_read_b64_tr_b16 v[222:223], v2 offset:29408
    v_mul_f32 v69, v69, v20
    v_mfma_f32_16x16x32_bf16 v[84:87], v[236:239], v[204:207], v[84:87]
    s_waitcnt lgkmcnt(8)
    ds_read_b64_tr_b16 v[224:225], v2 offset:33536
    v_mul_f32 v70, v70, v20
    v_mfma_f32_16x16x32_bf16 v[84:87], v[240:243], v[212:215], v[84:87]
    ds_read_b64_tr_b16 v[226:227], v2 offset:37664
    v_mul_f32 v71, v71, v20
    v_mfma_f32_16x16x32_bf16 v[88:91], v[228:231], v[192:195], v[88:91]
    ds_read_b64_tr_b16 v[228:229], v2 offset:41792
    v_cvt_pk_bf16_f32 v126, v68, v69
    v_mfma_f32_16x16x32_bf16 v[88:91], v[232:235], v[200:203], v[88:91]
    ds_read_b64_tr_b16 v[230:231], v2 offset:45920
    v_cvt_pk_bf16_f32 v127, v70, v71
    v_mfma_f32_16x16x32_bf16 v[88:91], v[236:239], v[208:211], v[88:91]
    ds_read_b64_tr_b16 v[232:233], v2 offset:50048
    buffer_store_dwordx4 v[124:127], v4, s[24:27], s37 offen offset:0 sc1 nt
    v_mfma_f32_16x16x32_bf16 v[88:91], v[240:243], v[216:219], v[88:91]
    s_waitcnt lgkmcnt(11)
    ds_read_b64_tr_b16 v[234:235], v2 offset:54176
    v_mul_f32 v72, v72, v24
    v_mfma_f32_16x16x32_bf16 v[92:95], v[244:247], v[156:159], 0
    s_waitcnt lgkmcnt(10)
    ds_read_b64_tr_b16 v[236:237], v2 offset:58304
    v_mul_f32 v73, v73, v24
    v_mfma_f32_16x16x32_bf16 v[92:95], v[248:251], v[164:167], v[92:95]
    s_waitcnt lgkmcnt(9)
    ds_read_b64_tr_b16 v[238:239], v2 offset:62432
    v_mul_f32 v74, v74, v24
    v_mfma_f32_16x16x32_bf16 v[92:95], v[252:255], v[172:175], v[92:95]
    s_waitcnt lgkmcnt(8)
    ds_read_b64_tr_b16 v[240:241], v2 offset:520
    v_mul_f32 v75, v75, v24
    v_mfma_f32_16x16x32_bf16 v[92:95], v[220:223], v[180:183], v[92:95]
    ds_read_b64_tr_b16 v[242:243], v2 offset:4648
    v_cvt_pk_bf16_f32 v130, v72, v73
    v_mfma_f32_16x16x32_bf16 v[96:99], v[244:247], v[160:163], 0
    ds_read_b64_tr_b16 v[244:245], v2 offset:8776
    v_cvt_pk_bf16_f32 v131, v74, v75
    v_mfma_f32_16x16x32_bf16 v[96:99], v[248:251], v[168:171], v[96:99]
    ds_read_b64_tr_b16 v[246:247], v2 offset:12904
    buffer_store_dwordx4 v[128:131], v4, s[24:27], s30 offen offset:0 sc1 nt
    v_mfma_f32_16x16x32_bf16 v[96:99], v[252:255], v[176:179], v[96:99]
    ds_read_b64_tr_b16 v[248:249], v2 offset:17032
    v_mul_f32 v76, v76, v20
    v_mfma_f32_16x16x32_bf16 v[96:99], v[220:223], v[184:187], v[96:99]
    s_waitcnt lgkmcnt(11)
    ds_read_b64_tr_b16 v[250:251], v2 offset:21160
    v_mul_f32 v77, v77, v20
    v_mfma_f32_16x16x32_bf16 v[92:95], v[224:227], v[188:191], v[92:95]
    s_waitcnt lgkmcnt(10)
    ds_read_b64_tr_b16 v[252:253], v2 offset:25288
    v_mul_f32 v78, v78, v20
    v_mfma_f32_16x16x32_bf16 v[92:95], v[228:231], v[196:199], v[92:95]
    s_waitcnt lgkmcnt(9)
    ds_read_b64_tr_b16 v[254:255], v2 offset:29416
    v_mul_f32 v79, v79, v20
    v_mfma_f32_16x16x32_bf16 v[92:95], v[232:235], v[204:207], v[92:95]
    s_waitcnt lgkmcnt(8)
    ds_read_b64_tr_b16 v[220:221], v2 offset:33544
    v_cvt_pk_bf16_f32 v132, v76, v77
    v_mfma_f32_16x16x32_bf16 v[92:95], v[236:239], v[212:215], v[92:95]
    ds_read_b64_tr_b16 v[222:223], v2 offset:37672
    v_cvt_pk_bf16_f32 v133, v78, v79
    v_mfma_f32_16x16x32_bf16 v[96:99], v[224:227], v[192:195], v[96:99]
    ds_read_b64_tr_b16 v[224:225], v2 offset:41800
    v_mul_f32 v80, v80, v24
    v_mfma_f32_16x16x32_bf16 v[96:99], v[228:231], v[200:203], v[96:99]
    ds_read_b64_tr_b16 v[226:227], v2 offset:45928
    v_mul_f32 v81, v81, v24
    v_mfma_f32_16x16x32_bf16 v[96:99], v[232:235], v[208:211], v[96:99]
    ds_read_b64_tr_b16 v[228:229], v2 offset:50056
    v_mul_f32 v82, v82, v24
    v_mfma_f32_16x16x32_bf16 v[96:99], v[236:239], v[216:219], v[96:99]
    s_waitcnt lgkmcnt(11)
    ds_read_b64_tr_b16 v[230:231], v2 offset:54184
    v_mul_f32 v83, v83, v24
    v_mfma_f32_16x16x32_bf16 v[100:103], v[240:243], v[156:159], 0
    s_waitcnt lgkmcnt(10)
    ds_read_b64_tr_b16 v[232:233], v2 offset:58312
    v_cvt_pk_bf16_f32 v136, v80, v81
    v_mfma_f32_16x16x32_bf16 v[100:103], v[244:247], v[164:167], v[100:103]
    s_waitcnt lgkmcnt(9)
    ds_read_b64_tr_b16 v[234:235], v2 offset:62440
    v_cvt_pk_bf16_f32 v137, v82, v83
    v_mfma_f32_16x16x32_bf16 v[100:103], v[248:251], v[172:175], v[100:103]
    s_waitcnt lgkmcnt(8)
    ds_read_b64_tr_b16 v[236:237], v2 offset:768
    v_mul_f32 v84, v84, v20
    v_mfma_f32_16x16x32_bf16 v[100:103], v[252:255], v[180:183], v[100:103]
    ds_read_b64_tr_b16 v[238:239], v2 offset:4896
    v_mul_f32 v85, v85, v20
    v_mfma_f32_16x16x32_bf16 v[104:107], v[240:243], v[160:163], 0
    ds_read_b64_tr_b16 v[240:241], v2 offset:9024
    v_mul_f32 v86, v86, v20
    v_mfma_f32_16x16x32_bf16 v[104:107], v[244:247], v[168:171], v[104:107]
    ds_read_b64_tr_b16 v[242:243], v2 offset:13152
    v_mul_f32 v87, v87, v20
    v_mfma_f32_16x16x32_bf16 v[104:107], v[248:251], v[176:179], v[104:107]
    ds_read_b64_tr_b16 v[244:245], v2 offset:17280
    v_cvt_pk_bf16_f32 v134, v84, v85
    v_mfma_f32_16x16x32_bf16 v[104:107], v[252:255], v[184:187], v[104:107]
    s_waitcnt lgkmcnt(11)
    ds_read_b64_tr_b16 v[246:247], v2 offset:21408
    v_cvt_pk_bf16_f32 v135, v86, v87
    v_mfma_f32_16x16x32_bf16 v[100:103], v[220:223], v[188:191], v[100:103]
    s_waitcnt lgkmcnt(10)
    ds_read_b64_tr_b16 v[248:249], v2 offset:25536
    buffer_store_dwordx4 v[132:135], v4, s[24:27], s37 offen offset:64 sc1 nt
    v_mfma_f32_16x16x32_bf16 v[100:103], v[224:227], v[196:199], v[100:103]
    s_waitcnt lgkmcnt(9)
    ds_read_b64_tr_b16 v[250:251], v2 offset:29664
    v_mul_f32 v88, v88, v24
    v_mfma_f32_16x16x32_bf16 v[100:103], v[228:231], v[204:207], v[100:103]
    s_waitcnt lgkmcnt(8)
    ds_read_b64_tr_b16 v[252:253], v2 offset:33792
    v_mul_f32 v89, v89, v24
    v_mfma_f32_16x16x32_bf16 v[100:103], v[232:235], v[212:215], v[100:103]
    ds_read_b64_tr_b16 v[254:255], v2 offset:37920
    v_mul_f32 v90, v90, v24
    v_mfma_f32_16x16x32_bf16 v[104:107], v[220:223], v[192:195], v[104:107]
    ds_read_b64_tr_b16 v[220:221], v2 offset:42048
    v_mul_f32 v91, v91, v24
    v_mfma_f32_16x16x32_bf16 v[104:107], v[224:227], v[200:203], v[104:107]
    ds_read_b64_tr_b16 v[222:223], v2 offset:46176
    v_cvt_pk_bf16_f32 v138, v88, v89
    v_mfma_f32_16x16x32_bf16 v[104:107], v[228:231], v[208:211], v[104:107]
    ds_read_b64_tr_b16 v[224:225], v2 offset:50304
    v_cvt_pk_bf16_f32 v139, v90, v91
    v_mfma_f32_16x16x32_bf16 v[104:107], v[232:235], v[216:219], v[104:107]
    s_waitcnt lgkmcnt(11)
    ds_read_b64_tr_b16 v[226:227], v2 offset:54432
    buffer_store_dwordx4 v[136:139], v4, s[24:27], s30 offen offset:64 sc1 nt
    v_mfma_f32_16x16x32_bf16 v[108:111], v[236:239], v[156:159], 0
    s_waitcnt lgkmcnt(10)
    ds_read_b64_tr_b16 v[228:229], v2 offset:58560
    v_mul_f32 v92, v92, v20
    v_mfma_f32_16x16x32_bf16 v[108:111], v[240:243], v[164:167], v[108:111]
    s_waitcnt lgkmcnt(9)
    ds_read_b64_tr_b16 v[230:231], v2 offset:62688
    v_mul_f32 v93, v93, v20
    v_mfma_f32_16x16x32_bf16 v[108:111], v[244:247], v[172:175], v[108:111]
    s_waitcnt lgkmcnt(8)
    ds_read_b64_tr_b16 v[232:233], v2 offset:776
    v_mul_f32 v94, v94, v20
    v_mfma_f32_16x16x32_bf16 v[108:111], v[248:251], v[180:183], v[108:111]
    ds_read_b64_tr_b16 v[234:235], v2 offset:4904
    v_mul_f32 v95, v95, v20
    v_mfma_f32_16x16x32_bf16 v[112:115], v[236:239], v[160:163], 0
    ds_read_b64_tr_b16 v[236:237], v2 offset:9032
    v_cvt_pk_bf16_f32 v124, v92, v93
    v_mfma_f32_16x16x32_bf16 v[112:115], v[240:243], v[168:171], v[112:115]
    ds_read_b64_tr_b16 v[238:239], v2 offset:13160
    v_cvt_pk_bf16_f32 v125, v94, v95
    v_mfma_f32_16x16x32_bf16 v[112:115], v[244:247], v[176:179], v[112:115]
    ds_read_b64_tr_b16 v[240:241], v2 offset:17288
    v_mul_f32 v96, v96, v24
    v_mfma_f32_16x16x32_bf16 v[112:115], v[248:251], v[184:187], v[112:115]
    s_waitcnt lgkmcnt(11)
    ds_read_b64_tr_b16 v[242:243], v2 offset:21416
    v_mul_f32 v97, v97, v24
    v_mfma_f32_16x16x32_bf16 v[108:111], v[252:255], v[188:191], v[108:111]
    s_waitcnt lgkmcnt(10)
    ds_read_b64_tr_b16 v[244:245], v2 offset:25544
    v_mul_f32 v98, v98, v24
    v_mfma_f32_16x16x32_bf16 v[108:111], v[220:223], v[196:199], v[108:111]
    s_waitcnt lgkmcnt(9)
    ds_read_b64_tr_b16 v[246:247], v2 offset:29672
    v_mul_f32 v99, v99, v24
    v_mfma_f32_16x16x32_bf16 v[108:111], v[224:227], v[204:207], v[108:111]
    s_waitcnt lgkmcnt(8)
    ds_read_b64_tr_b16 v[248:249], v2 offset:33800
    v_cvt_pk_bf16_f32 v128, v96, v97
    v_mfma_f32_16x16x32_bf16 v[108:111], v[228:231], v[212:215], v[108:111]
    ds_read_b64_tr_b16 v[250:251], v2 offset:37928
    v_cvt_pk_bf16_f32 v129, v98, v99
    v_mfma_f32_16x16x32_bf16 v[112:115], v[252:255], v[192:195], v[112:115]
    ds_read_b64_tr_b16 v[252:253], v2 offset:42056
    v_mul_f32 v100, v100, v20
    v_mfma_f32_16x16x32_bf16 v[112:115], v[220:223], v[200:203], v[112:115]
    ds_read_b64_tr_b16 v[254:255], v2 offset:46184
    v_mul_f32 v101, v101, v20
    v_mfma_f32_16x16x32_bf16 v[112:115], v[224:227], v[208:211], v[112:115]
    ds_read_b64_tr_b16 v[220:221], v2 offset:50312
    v_mul_f32 v102, v102, v20
    v_mfma_f32_16x16x32_bf16 v[112:115], v[228:231], v[216:219], v[112:115]
    s_waitcnt lgkmcnt(11)
    ds_read_b64_tr_b16 v[222:223], v2 offset:54440
    v_mul_f32 v103, v103, v20
    v_mfma_f32_16x16x32_bf16 v[116:119], v[232:235], v[156:159], 0
    s_waitcnt lgkmcnt(10)
    ds_read_b64_tr_b16 v[224:225], v2 offset:58568
    v_cvt_pk_bf16_f32 v126, v100, v101
    v_mfma_f32_16x16x32_bf16 v[116:119], v[236:239], v[164:167], v[116:119]
    s_waitcnt lgkmcnt(9)
    ds_read_b64_tr_b16 v[226:227], v2 offset:62696
    v_cvt_pk_bf16_f32 v127, v102, v103
    v_mfma_f32_16x16x32_bf16 v[116:119], v[240:243], v[172:175], v[116:119]
    s_waitcnt lgkmcnt(8)
    buffer_store_dwordx4 v[124:127], v4, s[24:27], s37 offen offset:128 sc1 nt
    v_mfma_f32_16x16x32_bf16 v[116:119], v[244:247], v[180:183], v[116:119]
    v_mul_f32 v104, v104, v24
    v_mul_f32 v105, v105, v24
    v_mfma_f32_16x16x32_bf16 v[120:123], v[232:235], v[160:163], 0
    v_mul_f32 v106, v106, v24
    v_mul_f32 v107, v107, v24
    v_mfma_f32_16x16x32_bf16 v[120:123], v[236:239], v[168:171], v[120:123]
    v_cvt_pk_bf16_f32 v130, v104, v105
    v_cvt_pk_bf16_f32 v131, v106, v107
    v_mfma_f32_16x16x32_bf16 v[120:123], v[240:243], v[176:179], v[120:123]
    buffer_store_dwordx4 v[128:131], v4, s[24:27], s30 offen offset:128 sc1 nt
    v_mfma_f32_16x16x32_bf16 v[120:123], v[244:247], v[184:187], v[120:123]
    s_waitcnt lgkmcnt(6)
    v_mul_f32 v108, v108, v20
    v_mul_f32 v109, v109, v20
    v_mfma_f32_16x16x32_bf16 v[116:119], v[248:251], v[188:191], v[116:119]
    s_waitcnt lgkmcnt(4)
    v_mul_f32 v110, v110, v20
    v_mul_f32 v111, v111, v20
    v_mfma_f32_16x16x32_bf16 v[116:119], v[252:255], v[196:199], v[116:119]
    s_waitcnt lgkmcnt(2)
    v_cvt_pk_bf16_f32 v132, v108, v109
    v_cvt_pk_bf16_f32 v133, v110, v111
    v_mfma_f32_16x16x32_bf16 v[116:119], v[220:223], v[204:207], v[116:119]
    s_waitcnt lgkmcnt(0)
    v_mul_f32 v112, v112, v24
    v_mul_f32 v113, v113, v24
    v_mfma_f32_16x16x32_bf16 v[116:119], v[224:227], v[212:215], v[116:119]
    v_mul_f32 v114, v114, v24
    v_mul_f32 v115, v115, v24
    v_mfma_f32_16x16x32_bf16 v[120:123], v[248:251], v[192:195], v[120:123]
    v_cvt_pk_bf16_f32 v136, v112, v113
    v_cvt_pk_bf16_f32 v137, v114, v115
    v_mfma_f32_16x16x32_bf16 v[120:123], v[252:255], v[200:203], v[120:123]
    v_mfma_f32_16x16x32_bf16 v[120:123], v[220:223], v[208:211], v[120:123]
    s_nop 0
    v_mul_f32 v116, v116, v20
    v_mul_f32 v117, v117, v20
    v_mfma_f32_16x16x32_bf16 v[120:123], v[224:227], v[216:219], v[120:123]
    v_mul_f32 v118, v118, v20
    v_mul_f32 v119, v119, v20
    s_setprio 0
    v_cvt_pk_bf16_f32 v134, v116, v117
    v_cvt_pk_bf16_f32 v135, v118, v119
    buffer_store_dwordx4 v[132:135], v4, s[24:27], s37 offen offset:192 sc1 nt
    s_nop 1
    v_mul_f32 v120, v120, v24
    v_mul_f32 v121, v121, v24
    v_mul_f32 v122, v122, v24
    v_mul_f32 v123, v123, v24
    v_cvt_pk_bf16_f32 v138, v120, v121
    v_cvt_pk_bf16_f32 v139, v122, v123
    buffer_store_dwordx4 v[136:139], v4, s[24:27], s30 offen offset:192 sc1 nt
    s_endpgm
L_spin1:
    ds_read_b32 v5, v6 offset:16
    s_sub_u32 s53, s53, 1
    s_cbranch_scc1 L_end
    s_waitcnt lgkmcnt(0)
    v_cmp_ne_u32 vcc, 0, v5
    s_cbranch_vccnz L_spin1
    s_branch L_back1
L_spin3:
    ds_read_b32 v5, v6 offset:48
    s_sub_u32 s53, s53, 1
    s_cbranch_scc1 L_end
    s_waitcnt lgkmcnt(0)
    v_cmp_ne_u32 vcc, 0, v5
    s_cbranch_vccnz L_spin3
    s_branch L_back3
L_spin4:
    ds_read_b32 v5, v6 offset:64
    s_sub_u32 s53, s53, 1
    s_cbranch_scc1 L_end
    s_waitcnt lgkmcnt(0)
    v_cmp_ne_u32 vcc, 0, v5
    s_cbranch_vccnz L_spin4
    s_branch L_back4
L_spin5:
    ds_read_b32 v5, v6 offset:80
    s_sub_u32 s53, s53, 1
    s_cbranch_scc1 L_end
    s_waitcnt lgkmcnt(0)
    v_cmp_ne_u32 vcc, 0, v5
    s_cbranch_vccnz L_spin5
    s_branch L_back5
L_spin6:
    ds_read_b32 v5, v6 offset:96
    s_sub_u32 s53, s53, 1
    s_cbranch_scc1 L_end
    s_waitcnt lgkmcnt(0)
    v_cmp_ne_u32 vcc, 0, v5
    s_cbranch_vccnz L_spin6
    s_branch L_back6
L_spin7:
    ds_read_b32 v5, v6 offset:112
    s_sub_u32 s53, s53, 1
    s_cbranch_scc1 L_end
    s_waitcnt lgkmcnt(0)
    v_cmp_ne_u32 vcc, 0, v5
    s_cbranch_vccnz L_spin7
    s_branch L_back7
L_slow:
    s_mov_b64 s[32:33], 0
L_pslow:
    ds_read_b32 v5, v6 offset:112
    s_sub_u32 s53, s53, 1
    s_cbranch_scc1 L_end
    s_waitcnt lgkmcnt(0)
    v_cmp_ne_u32 vcc, 0, v5
    s_cbranch_vccnz L_pslow
    s_nop 15
    s_nop 15
    v_mov_b32 v7, v1
    v_mov_b32 v20, 0xff800000
    v_mov_b32 v24, 0xff800000
    s_mov_b32 s42, 16
L_slow_loop:
    ds_read_b128 v[220:223], v7 offset:0
    ds_read_b128 v[224:227], v7 offset:256
    ds_read_b128 v[228:231], v7 offset:512
    ds_read_b128 v[232:235], v7 offset:768
    s_waitcnt lgkmcnt(0)
    v_mfma_f32_16x16x32_bf16 v[124:127], v[220:223], v[28:31], 0
    v_mfma_f32_16x16x32_bf16 v[124:127], v[224:227], v[32:35], v[124:127]
    v_mfma_f32_16x16x32_bf16 v[124:127], v[228:231], v[36:39], v[124:127]
    v_mfma_f32_16x16x32_bf16 v[124:127], v[232:235], v[40:43], v[124:127]
    v_mfma_f32_16x16x32_bf16 v[128:131], v[220:223], v[44:47], 0
    v_mfma_f32_16x16x32_bf16 v[128:131], v[224:227], v[48:51], v[128:131]
    v_mfma_f32_16x16x32_bf16 v[128:131], v[228:231], v[52:55], v[128:131]
    v_mfma_f32_16x16x32_bf16 v[128:131], v[232:235], v[56:59], v[128:131]
    s_nop 15
    v_max3_f32 v20, v20, v124, v125
    v_max3_f32 v20, v20, v126, v127
    v_max3_f32 v24, v24, v128, v129
    v_max3_f32 v24, v24, v130, v131
    v_add_u32 v7, 4096, v7
    s_sub_u32 s42, s42, 1
    s_cmp_lg_u32 s42, 0
    s_cbranch_scc1 L_slow_loop
    v_mov_b32 v21, v20
    s_nop 1
    v_permlane16_swap_b32 v20, v21
    s_nop 1
    v_max_f32 v20, v20, v21
    v_mov_b32 v21, v20
    s_nop 1
    v_permlane32_swap_b32 v20, v21
    s_nop 1
    v_max_f32 v20, v20, v21
    v_sub_f32 v8, 0, v20
    v_sub_f32 v9, 0, v20
    v_sub_f32 v10, 0, v20
    v_sub_f32 v11, 0, v20
    v_mov_b32 v25, v24
    s_nop 1
    v_permlane16_swap_b32 v24, v25
    s_nop 1
    v_max_f32 v24, v24, v25
    v_mov_b32 v25, v24
    s_nop 1
    v_permlane32_swap_b32 v24, v25
    s_nop 1
    v_max_f32 v24, v24, v25
    v_sub_f32 v12, 0, v24
    v_sub_f32 v13, 0, v24
    v_sub_f32 v14, 0, v24
    v_sub_f32 v15, 0, v24
    ds_read_b128 v[220:223], v1 offset:0
    ds_read_b128 v[224:227], v1 offset:256
    ds_read_b128 v[228:231], v1 offset:512
    ds_read_b128 v[232:235], v1 offset:768
    ds_read_b128 v[236:239], v1 offset:4096
    ds_read_b128 v[240:243], v1 offset:4352
    s_nop 7
    s_branch L_mainB
L_codeend:
.section .rodata,"a"
.p2align 6
.amdhsa_kernel standalone__gqa_softmax__near_ridge_kernel
  .amdhsa_next_free_vgpr 256
  .amdhsa_next_free_sgpr 102
  .amdhsa_accum_offset 256
  .amdhsa_group_segment_fixed_size 0
  .amdhsa_kernarg_size 48
  .amdhsa_user_sgpr_count 2
  .amdhsa_user_sgpr_kernarg_segment_ptr 1
  .amdhsa_system_sgpr_workgroup_id_x 1
.end_amdhsa_kernel
```
